```python
import torch

def _softmax(x, axis=-1):
    return torch.softmax(x, dim=axis)
def _gelu(x):
    return torch.nn.functional.gelu(x, approximate="tanh")
def _silu(x):
    return torch.nn.functional.silu(x)
def _sigmoid(x):
    return torch.sigmoid(x)
def _layernorm(x, axis=-1, eps=1e-5):
    m = x.mean(dim=axis, keepdim=True)
    v = x.var(dim=axis, keepdim=True, unbiased=False)
    return (x - m) / torch.sqrt(v + eps)
def _scatter_add(tgt, idx, src, axis=0):
    return tgt.clone().index_add_(axis, idx, src)
def _segment_sum(src, seg, n):
    out = torch.zeros((n,) + src.shape[1:], dtype=src.dtype)
    return out.index_add_(0, seg, src)
def _pad(x, pw):
    flat = tuple(v for pair in reversed(pw) for v in pair)
    return torch.nn.functional.pad(x, flat)

kernel_name = 'interleave_layers__grouped_kv_mqa__moe_arch_mod__prompt'

def setup_inputs():

    _w = (lambda a: (lambda t: t.to(torch.bfloat16) if t.is_floating_point() else t)(torch.as_tensor(a)))
    def _A_setup():
        B, S, D, H = 1, 2048, 512, 32
        Dh = D // H
        return {
            "x": _w((lambda *s: torch.randn(*s, dtype=torch.bfloat16) * 0.05)(B, S, D)),
            "wq": _w((lambda *s: torch.randn(*s, dtype=torch.bfloat16) * 0.05)(D, H * Dh)),
            "wk": _w((lambda *s: torch.randn(*s, dtype=torch.bfloat16) * 0.05)(D, Dh)),
            "wv": _w((lambda *s: torch.randn(*s, dtype=torch.bfloat16) * 0.05)(D, Dh)),
            "wo": _w((lambda *s: torch.randn(*s, dtype=torch.bfloat16) * 0.05)(H * Dh, D)),
        }
    _A_in = _A_setup()

    def _B_setup():
        B, S, D, F, C = 1, 2048, 512, 1792, 1
        return {
            "x": _w((lambda *s: torch.randn(*s, dtype=torch.bfloat16) * 0.05)(B, S, D)),
            "w_r": _w((lambda *s: torch.randn(*s, dtype=torch.bfloat16) * 0.05)(D)),
            "w_gate": _w((lambda *s: torch.randn(*s, dtype=torch.bfloat16) * 0.05)(D, F)),
            "w_up": _w((lambda *s: torch.randn(*s, dtype=torch.bfloat16) * 0.05)(D, F)),
            "w_down": _w((lambda *s: torch.randn(*s, dtype=torch.bfloat16) * 0.05)(F, D)),
        }
    _B_in = _B_setup()

    return {
        "A_x": _A_in["x"],
        "A_wq": _A_in["wq"],
        "A_wk": _A_in["wk"],
        "A_wv": _A_in["wv"],
        "A_wo": _A_in["wo"],
        "B_x": _B_in["x"],
        "B_w_r": _B_in["w_r"],
        "B_w_gate": _B_in["w_gate"],
        "B_w_up": _B_in["w_up"],
        "B_w_down": _B_in["w_down"],
    }

def reference(A_x, A_wq, A_wk, A_wv, A_wo, B_x, B_w_r, B_w_gate, B_w_up, B_w_down):
    def _A_ref(x, wq, wk, wv, wo):
        B, S, D = x.shape
        H = 32
        Dh = D // H
        q = (lambda x, *d: x.permute(*d))((x @ wq).reshape(B, S, H, Dh), 0, 2, 1, 3)
        k = x @ wk
        v = x @ wv
        scores = torch.einsum("bhqd,bkd->bhqk", q, k) * (Dh ** -0.5)
        p = _softmax(scores, axis=-1)
        o = torch.einsum("bhqk,bkd->bhqd", p, v)
        return (lambda x, *d: x.permute(*d))(o, 0, 2, 1, 3).reshape(B, S, H * Dh) @ wo

    def _B_ref(x, w_r, w_gate, w_up, w_down):
        B, S, D = x.shape
        C = 1
        r = x @ w_r
        idx = torch.argsort(-r, axis=-1)[:, :C]
        idx_e = (lambda x, n, axis: torch.repeat_interleave(x, n, dim=axis))(idx.reshape(B, C, 1), D, axis=2)
        x_sel = (lambda x, i, axis: torch.take_along_dim(x, i, dim=axis))(x, idx_e, axis=1)
        g = _silu(x_sel @ w_gate)
        u = x_sel @ w_up
        y = (g * u) @ w_down
        r_sel = _sigmoid((lambda x, i, axis: torch.take_along_dim(x, i, dim=axis))(r, idx, axis=1))
        y = y * r_sel.reshape(B, C, 1)
        b_off = (torch.arange(B) * S).reshape(B, 1)
        flat_idx = (idx + b_off).reshape(B * C)
        zero = (x * 0.0).reshape(B * S, D)
        upd = _scatter_add(zero, flat_idx, y.reshape(B * C, D), axis=0)
        return x + upd.reshape(B, S, D)

    x = A_x
    x = x + _A_ref(_layernorm(x, axis=-1), A_wq, A_wk, A_wv, A_wo)
    x = x + _B_ref(_layernorm(x, axis=-1), B_w_r, B_w_gate, B_w_up, B_w_down)
    x = x + _A_ref(_layernorm(x, axis=-1), A_wq, A_wk, A_wv, A_wo)
    x = x + _B_ref(_layernorm(x, axis=-1), B_w_r, B_w_gate, B_w_up, B_w_down)
    return x
```

```asm
; @launch grid=(256,1,1) block=(512,1,1) lds=163840
.amdgcn_target "amdgcn-amd-amdhsa--gfx950"
.text
.globl interleave_layers__grouped_kv_mqa__moe_arch_mod__prompt_kernel
.p2align 8
.type interleave_layers__grouped_kv_mqa__moe_arch_mod__prompt_kernel,@function
interleave_layers__grouped_kv_mqa__moe_arch_mod__prompt_kernel:
    s_cmp_ge_u32 s2, 256
    s_cbranch_scc1 L_exit
    s_load_dwordx16 s[8:23], s[0:1], 0
    s_load_dwordx8 s[24:31], s[0:1], 64
    s_load_dwordx2 s[32:33], s[0:1], 96
    v_lshrrev_b32 v1, 6, v0
    v_and_b32 v0, 63, v0
    s_mov_b32 s36, 0
    v_readfirstlane_b32 s35, v1
    s_mov_b32 s39, 0x05040100
    s_mov_b32 s40, 0x07060302
    s_mov_b32 s54, 0
    s_and_b32 s41, s2, 7
    s_lshl_b32 s41, s41, 3
    s_bfe_u32 s42, s2, 0x30003
    s_or_b32 s41, s41, s42
    s_andn2_b32 s42, s2, 63
    s_or_b32 s96, s41, s42
    s_mov_b32 s52, -1
    s_and_b32 s47, s2, 7
    s_lshl_b32 s47, s47, 5
    s_lshr_b32 s41, s2, 3
    s_add_u32 s47, s47, s41
    s_and_b32 s51, s35, 3
    s_mov_b32 s100, s2
    s_nop 0
    s_and_b32 s37, s2, 3
    s_lshl_b32 s49, s2, 3
    s_add_u32 s49, s49, s35
    s_lshl_b32 s41, s49, 10
    v_lshl_add_u32 v1, v0, 4, s41
    v_mov_b64 v[12:13], -1
    v_mov_b64 v[14:15], -1
    s_cmp_lg_u32 s35, 7
    s_cbranch_scc1 S_z
    v_lshlrev_b32 v2, 4, v0
    v_add_u32 v2, 156160, v2
    ds_write_b128 v2, v[12:15]
    ds_write_b128 v2, v[12:15] offset:1024
    ds_write_b128 v2, v[12:15] offset:2048
    ds_write_b128 v2, v[12:15] offset:3072
    v_mov_b64 v[8:9], 0
    v_mov_b64 v[10:11], 0
    ds_write_b128 v2, v[8:11] offset:4608
S_z:
    s_waitcnt lgkmcnt(0)
    s_mov_b32 s18, s2
    s_mov_b32 s19, 0
    global_load_dwordx4 v[4:7], v1, s[8:9]
    s_barrier
    s_cmp_ge_u32 s35, 4
    s_cbranch_scc1 S_noA
    s_setprio 2
    v_add_u32 v16, 4096, v1
    global_load_dwordx4 v[224:227], v16, s[8:9]
    s_add_u32 s44, s51, 0
    s_lshl_b32 s41, s37, 3
    s_add_u32 s41, s41, s44
    s_add_u32 s41, s41, 8
    s_and_b32 s41, s41, 31
    s_andn2_b32 s43, s49, 31
    s_add_u32 s41, s41, s43
    s_lshl_b32 s41, s41, 10
    s_add_u32 s41, s41, 2048
    v_lshl_add_u32 v16, v0, 4, s41
    s_add_u32 s44, s51, 8
    s_lshl_b32 s41, s37, 3
    s_add_u32 s41, s41, s44
    s_add_u32 s41, s41, 8
    s_and_b32 s41, s41, 31
    s_andn2_b32 s43, s49, 31
    s_add_u32 s41, s41, s43
    s_lshl_b32 s41, s41, 10
    s_add_u32 s41, s41, 2048
    v_lshl_add_u32 v17, v0, 4, s41
    s_lshl_b32 s98, s51, 13
    s_add_u32 s98, s98, 114688
    s_cmp_eq_u32 s51, 3
    s_cselect_b32 s98, 147456, s98
    s_lshl_b32 s41, s51, 12
    v_lshl_add_u32 v8, v0, 4, s41
    s_mov_b32 m0, s98
    s_nop 0
    global_load_lds_dwordx4 v8, s[12:13] offset:0
    global_load_lds_dwordx4 v8, s[12:13] offset:1024
    global_load_lds_dwordx4 v8, s[12:13] offset:2048
    global_load_lds_dwordx4 v8, s[12:13] offset:3072
    s_add_u32 m0, s98, 4096
    s_nop 0
    global_load_lds_dwordx4 v8, s[14:15] offset:0
    global_load_lds_dwordx4 v8, s[14:15] offset:1024
    global_load_lds_dwordx4 v8, s[14:15] offset:2048
    global_load_lds_dwordx4 v8, s[14:15] offset:3072
    global_load_dwordx4 v[228:231], v16, s[8:9] offset:-2048
    global_load_dwordx4 v[232:235], v16, s[8:9] offset:2048
    global_load_dwordx4 v[236:239], v17, s[8:9] offset:-2048
    global_load_dwordx4 v[240:243], v17, s[8:9] offset:2048
    s_waitcnt vmcnt(12)
    s_branch R_P1
S_noA:
    s_load_dword s34, s[32:33], 0
    s_cmp_lg_u32 s35, 7
    s_cbranch_scc1 S_n7
    s_setprio 3
    s_mul_i32 s41, s96, 640
    s_add_u32 s41, s41, 196608
    v_lshl_add_u32 v1, v0, 4, s41
    v_add_u32 v3, 163840, v1
    v_mov_b32 v16, 0x3f803f80
    v_cmp_eq_u32 vcc, 32, v0
    s_nop 1
    v_cndmask_b32 v16, 0, v16, vcc
    v_cmp_gt_u32 vcc, 32, v0
    s_nop 1
    v_cndmask_b32 v16, v16, v12, vcc
    v_mov_b32 v17, v16
    v_mov_b64 v[18:19], v[16:17]
    s_mov_b32 exec_hi, 0xff
    global_store_dwordx4 v1, v[16:19], s[32:33] sc1
    global_store_dwordx4 v3, v[16:19], s[32:33] sc1
    s_mov_b32 exec_hi, -1
    s_lshl_b32 s41, s2, 7
    s_add_u32 s41, s41, 4194304
    s_lshl_b32 s42, s47, 7
    s_add_u32 s42, s42, 4194304
    v_mov_b32 v1, s41
    v_mov_b32 v3, s42
    v_cmp_gt_u32 vcc, 2, v0
    s_nop 1
    v_cndmask_b32 v1, v3, v1, vcc
    v_lshl_add_u32 v1, v0, 15, v1
    s_mov_b64 exec, 0x1f
    global_store_dwordx4 v1, v[12:15], s[32:33] sc1
    s_mov_b64 exec, -1
S_n7:
    s_lshr_b32 s43, s100, 3
    s_cmp_lg_u32 s35, 4
    s_cbranch_scc1 S_n4
    s_setprio 3
    v_lshrrev_b32 v1, 2, v0
    v_and_b32 v3, 3, v0
    v_lshlrev_b32 v3, 6, v3
    v_lshl_add_u32 v1, v1, 10, v3
    s_lshl_b32 s41, s43, 14
    s_lshl_b32 s42, s37, 8
    s_add_u32 s41, s41, s42
    v_add_u32 v1, s41, v1
    global_load_dword v40, v1, s[10:11]
S_n4:
    s_cmp_lg_u32 s35, 5
    s_cbranch_scc1 S_n5
    s_lshl_b32 s41, s43, 12
    s_lshl_b32 s42, s37, 17
    s_add_u32 s41, s41, s42
    v_lshl_add_u32 v1, v0, 6, s41
    global_load_dword v41, v1, s[16:17]
S_n5:
    s_setprio 1
    s_cmp_lg_u32 s35, 6
    s_cbranch_scc1 H_stage
    v_lshlrev_b32 v1, 4, v0
    global_load_dwordx4 v[44:47], v1, s[20:21]
    s_branch H_stage
R_P1:
    v_lshlrev_b32 v8, 16, v4
    v_and_b32 v9, 0xffff0000, v4
    v_lshlrev_b32 v10, 16, v5
    v_and_b32 v11, 0xffff0000, v5
    v_lshlrev_b32 v12, 16, v6
    v_and_b32 v13, 0xffff0000, v6
    v_lshlrev_b32 v14, 16, v7
    v_and_b32 v15, 0xffff0000, v7
R_P1b:
    v_readfirstlane_b32 s42, v8
    s_nop 1
    v_pk_add_f32 v[16:17], v[8:9], s[42:43] op_sel_hi:[1,0] neg_lo:[0,1] neg_hi:[0,1]
    v_pk_add_f32 v[18:19], v[10:11], s[42:43] op_sel_hi:[1,0] neg_lo:[0,1] neg_hi:[0,1]
    v_pk_add_f32 v[20:21], v[12:13], s[42:43] op_sel_hi:[1,0] neg_lo:[0,1] neg_hi:[0,1]
    v_pk_add_f32 v[22:23], v[14:15], s[42:43] op_sel_hi:[1,0] neg_lo:[0,1] neg_hi:[0,1]
    v_pk_add_f32 v[24:25], v[16:17], v[18:19]
    v_pk_mul_f32 v[26:27], v[16:17], v[16:17]
    v_pk_add_f32 v[24:25], v[24:25], v[20:21]
    v_pk_fma_f32 v[26:27], v[18:19], v[18:19], v[26:27]
    v_pk_add_f32 v[24:25], v[24:25], v[22:23]
    v_pk_fma_f32 v[26:27], v[20:21], v[20:21], v[26:27]
    v_add_f32 v24, v24, v25
    v_pk_fma_f32 v[26:27], v[22:23], v[22:23], v[26:27]
    v_mul_f32 v24, 0x3b000000, v24
    v_add_f32 v25, v26, v27
    s_nop 0
    v_add_f32_dpp v24, v24, v24 row_ror:8 row_mask:0xf bank_mask:0xf
    v_add_f32_dpp v25, v25, v25 row_ror:8 row_mask:0xf bank_mask:0xf
    s_nop 0
    v_add_f32_dpp v24, v24, v24 row_ror:4 row_mask:0xf bank_mask:0xf
    v_add_f32_dpp v25, v25, v25 row_ror:4 row_mask:0xf bank_mask:0xf
    s_nop 0
    v_add_f32_dpp v24, v24, v24 row_ror:2 row_mask:0xf bank_mask:0xf
    v_add_f32_dpp v25, v25, v25 row_ror:2 row_mask:0xf bank_mask:0xf
    s_nop 0
    v_add_f32_dpp v24, v24, v24 row_ror:1 row_mask:0xf bank_mask:0xf
    v_add_f32_dpp v25, v25, v25 row_ror:1 row_mask:0xf bank_mask:0xf
    s_nop 0
    v_add_f32_dpp v24, v24, v24 row_bcast:15 row_mask:0xa bank_mask:0xf
    v_add_f32_dpp v25, v25, v25 row_bcast:15 row_mask:0xa bank_mask:0xf
    s_nop 0
    v_add_f32_dpp v24, v24, v24 row_bcast:31 row_mask:0xc bank_mask:0xf
    v_add_f32_dpp v25, v25, v25 row_bcast:31 row_mask:0xc bank_mask:0xf
    v_mul_f32 v25, 0x3b000000, v25
    v_fma_f32 v25, -v24, v24, v25
    v_max_f32 v25, 0, v25
    v_add_f32 v25, 0x3727c5ac, v25
    v_rsq_f32 v25, v25
    s_nop 0
    v_mul_f32 v24, v24, v25
    v_readlane_b32 s42, v25, 63
    v_readlane_b32 s43, v24, 63
    s_nop 1
    v_pk_fma_f32 v[16:17], v[16:17], s[42:43], s[42:43] op_sel:[0,0,1] op_sel_hi:[1,0,1] neg_lo:[0,0,1] neg_hi:[0,0,1]
    v_pk_fma_f32 v[18:19], v[18:19], s[42:43], s[42:43] op_sel:[0,0,1] op_sel_hi:[1,0,1] neg_lo:[0,0,1] neg_hi:[0,0,1]
    v_pk_fma_f32 v[20:21], v[20:21], s[42:43], s[42:43] op_sel:[0,0,1] op_sel_hi:[1,0,1] neg_lo:[0,0,1] neg_hi:[0,0,1]
    v_pk_fma_f32 v[22:23], v[22:23], s[42:43], s[42:43] op_sel:[0,0,1] op_sel_hi:[1,0,1] neg_lo:[0,0,1] neg_hi:[0,0,1]
    v_cvt_pk_bf16_f32 v36, v16, v17
    v_cvt_pk_bf16_f32 v37, v18, v19
    v_cvt_pk_bf16_f32 v38, v20, v21
    v_cvt_pk_bf16_f32 v39, v22, v23
    s_add_u32 s41, s35, 8
    v_xor_b32 v2, s41, v0
    s_add_u32 s41, s35, 24
    s_lshl_b32 s41, s41, 10
    s_add_u32 s41, s41, 114688
    v_lshl_add_u32 v2, v2, 4, s41
    ds_write_b128 v2, v[36:39]
    s_cmp_eq_u32 s36, 0
    s_cbranch_scc1 S_l0
    s_lshl_b32 s41, s49, 10
    s_add_u32 s41, s41, 2097152
    v_lshl_add_u32 v2, v0, 4, s41
    s_cmp_ge_u32 s35, 4
    s_cbranch_scc1 R_nw
    s_waitcnt vmcnt(1)
    s_cmp_eq_u32 s6, 7
    s_cbranch_scc1 R_nw
    s_waitcnt vmcnt(0)
R_nw:
    global_store_dwordx4 v2, v[36:39], s[32:33] sc1
    s_cmp_ge_u32 s35, 4
    s_cbranch_scc1 H_B1
    s_setprio 3
    v_lshrrev_b32 v8, 4, v0
    v_and_b32 v9, 15, v0
    v_lshlrev_b32 v9, 3, v9
    v_lshl_add_u32 v8, v8, 8, v9
    v_add_u32 v8, s98, v8
    ds_read_b64_tr_b16 v[64:65], v8 offset:0
    ds_read_b64_tr_b16 v[66:67], v8 offset:128
    ds_read_b64_tr_b16 v[68:69], v8 offset:4096
    ds_read_b64_tr_b16 v[70:71], v8 offset:4224
    ds_read_b64_tr_b16 v[72:73], v8 offset:1024
    ds_read_b64_tr_b16 v[74:75], v8 offset:1152
    ds_read_b64_tr_b16 v[76:77], v8 offset:5120
    ds_read_b64_tr_b16 v[78:79], v8 offset:5248
    ds_read_b64_tr_b16 v[80:81], v8 offset:2048
    ds_read_b64_tr_b16 v[82:83], v8 offset:2176
    ds_read_b64_tr_b16 v[84:85], v8 offset:6144
    ds_read_b64_tr_b16 v[86:87], v8 offset:6272
    s_waitcnt lgkmcnt(4)
    ds_read_b64_tr_b16 v[88:89], v8 offset:3072
    ds_read_b64_tr_b16 v[90:91], v8 offset:3200
    ds_read_b64_tr_b16 v[92:93], v8 offset:7168
    ds_read_b64_tr_b16 v[94:95], v8 offset:7296
A_kvp:
    v_and_b32 v8, 7, v0
    v_add_u32 v8, 8, v8
    v_lshrrev_b32 v9, 4, v0
    v_xor_b32 v9, v9, v8
    v_lshlrev_b32 v8, 10, v8
    s_lshl_b32 s41, s51, 8
    s_add_u32 s41, s41, 131072
    v_add_u32 v8, s41, v8
    v_xor_b32 v10, 4, v9
    v_xor_b32 v11, 8, v9
    v_xor_b32 v12, 12, v9
    v_lshl_add_u32 v9, v9, 4, v8
    v_lshl_add_u32 v10, v10, 4, v8
    v_lshl_add_u32 v11, v11, 4, v8
    v_lshl_add_u32 v12, v12, 4, v8
    s_cmp_eq_u32 s36, 0
    s_cbranch_scc1 A_kv2
    s_waitcnt lgkmcnt(0)
    s_barrier
A_kv2:
    ds_read_b128 v[40:43], v9
    ds_read_b128 v[44:47], v10
    ds_read_b128 v[48:51], v11
    ds_read_b128 v[52:55], v12
    s_lshl_b32 s41, s51, 11
    s_add_u32 s41, s41, 147456
    v_lshl_add_u32 v8, v0, 4, s41
    s_lshl_b32 s42, s36, 2
    v_add_u32 v9, s42, v3
    v_mov_b32 v10, 1
    s_waitcnt lgkmcnt(3)
    v_mfma_f32_16x16x32_bf16 v[56:59], v[64:67], v[40:43], 0
    v_mfma_f32_16x16x32_bf16 v[60:63], v[40:43], v[68:71], 0
    s_waitcnt lgkmcnt(2)
    v_mfma_f32_16x16x32_bf16 v[56:59], v[72:75], v[44:47], v[56:59]
    v_mfma_f32_16x16x32_bf16 v[60:63], v[44:47], v[76:79], v[60:63]
    s_waitcnt lgkmcnt(1)
    v_mfma_f32_16x16x32_bf16 v[56:59], v[80:83], v[48:51], v[56:59]
    v_mfma_f32_16x16x32_bf16 v[60:63], v[48:51], v[84:87], v[60:63]
    s_waitcnt lgkmcnt(0)
    v_mfma_f32_16x16x32_bf16 v[56:59], v[88:91], v[52:55], v[56:59]
    v_mfma_f32_16x16x32_bf16 v[60:63], v[52:55], v[92:95], v[60:63]
    s_nop 6
    ds_write_b128 v8, v[56:59]
    ds_write_b128 v8, v[60:63] offset:1024
    s_mov_b64 exec, 1
    ds_add_u32 v9, v10 offset:0
    s_mov_b64 exec, -1
A_nokv:
    s_setprio 0
    s_cmp_lg_u32 s36, 0
    s_cbranch_scc1 R_cand
    s_setprio 2
    s_load_dword s34, s[32:33], 0
    s_mov_b32 s45, 5
    s_mov_b32 s3, s51
    s_branch S_fl
S_l0:
    v_mov_b32 v3, 160768
    s_mov_b32 s44, 0
    s_mov_b32 s45, 1
    s_add_u32 s3, s51, 28
S_fl:
    s_lshl_b32 s41, s44, 2
    s_set_gpr_idx_on s41, gpr_idx(SRC0)
    s_nop 1
    v_mov_b32 v28, v224
    v_mov_b32 v29, v225
    v_mov_b32 v30, v226
    v_mov_b32 v31, v227
    s_nop 1
    s_set_gpr_idx_off
    v_lshlrev_b32 v40, 16, v28
    v_and_b32 v41, 0xffff0000, v28
    v_lshlrev_b32 v42, 16, v29
    v_and_b32 v43, 0xffff0000, v29
    v_lshlrev_b32 v44, 16, v30
    v_and_b32 v45, 0xffff0000, v30
    v_lshlrev_b32 v46, 16, v31
    v_and_b32 v47, 0xffff0000, v31
    v_readfirstlane_b32 s42, v40
    s_nop 1
    v_pk_add_f32 v[16:17], v[40:41], s[42:43] op_sel_hi:[1,0] neg_lo:[0,1] neg_hi:[0,1]
    v_pk_add_f32 v[18:19], v[42:43], s[42:43] op_sel_hi:[1,0] neg_lo:[0,1] neg_hi:[0,1]
    v_pk_add_f32 v[20:21], v[44:45], s[42:43] op_sel_hi:[1,0] neg_lo:[0,1] neg_hi:[0,1]
    v_pk_add_f32 v[22:23], v[46:47], s[42:43] op_sel_hi:[1,0] neg_lo:[0,1] neg_hi:[0,1]
    v_pk_add_f32 v[24:25], v[16:17], v[18:19]
    v_pk_mul_f32 v[26:27], v[16:17], v[16:17]
    v_pk_add_f32 v[24:25], v[24:25], v[20:21]
    v_pk_fma_f32 v[26:27], v[18:19], v[18:19], v[26:27]
    v_pk_add_f32 v[24:25], v[24:25], v[22:23]
    v_pk_fma_f32 v[26:27], v[20:21], v[20:21], v[26:27]
    v_add_f32 v24, v24, v25
    v_pk_fma_f32 v[26:27], v[22:23], v[22:23], v[26:27]
    v_mul_f32 v24, 0x3b000000, v24
    v_add_f32 v25, v26, v27
    s_nop 0
    v_add_f32_dpp v24, v24, v24 row_ror:8 row_mask:0xf bank_mask:0xf
    v_add_f32_dpp v25, v25, v25 row_ror:8 row_mask:0xf bank_mask:0xf
    s_nop 0
    v_add_f32_dpp v24, v24, v24 row_ror:4 row_mask:0xf bank_mask:0xf
    v_add_f32_dpp v25, v25, v25 row_ror:4 row_mask:0xf bank_mask:0xf
    s_nop 0
    v_add_f32_dpp v24, v24, v24 row_ror:2 row_mask:0xf bank_mask:0xf
    v_add_f32_dpp v25, v25, v25 row_ror:2 row_mask:0xf bank_mask:0xf
    s_nop 0
    v_add_f32_dpp v24, v24, v24 row_ror:1 row_mask:0xf bank_mask:0xf
    v_add_f32_dpp v25, v25, v25 row_ror:1 row_mask:0xf bank_mask:0xf
    s_nop 0
    v_add_f32_dpp v24, v24, v24 row_bcast:15 row_mask:0xa bank_mask:0xf
    v_add_f32_dpp v25, v25, v25 row_bcast:15 row_mask:0xa bank_mask:0xf
    s_nop 0
    v_add_f32_dpp v24, v24, v24 row_bcast:31 row_mask:0xc bank_mask:0xf
    v_add_f32_dpp v25, v25, v25 row_bcast:31 row_mask:0xc bank_mask:0xf
    v_mul_f32 v25, 0x3b000000, v25
    v_fma_f32 v25, -v24, v24, v25
    v_max_f32 v25, 0, v25
    v_add_f32 v25, 0x3727c5ac, v25
    v_rsq_f32 v25, v25
    s_nop 0
    v_mul_f32 v24, v24, v25
    v_readlane_b32 s42, v25, 63
    v_readlane_b32 s43, v24, 63
    s_nop 1
    v_pk_fma_f32 v[16:17], v[16:17], s[42:43], s[42:43] op_sel:[0,0,1] op_sel_hi:[1,0,1] neg_lo:[0,0,1] neg_hi:[0,0,1]
    v_pk_fma_f32 v[18:19], v[18:19], s[42:43], s[42:43] op_sel:[0,0,1] op_sel_hi:[1,0,1] neg_lo:[0,0,1] neg_hi:[0,0,1]
    v_pk_fma_f32 v[20:21], v[20:21], s[42:43], s[42:43] op_sel:[0,0,1] op_sel_hi:[1,0,1] neg_lo:[0,0,1] neg_hi:[0,0,1]
    v_pk_fma_f32 v[22:23], v[22:23], s[42:43], s[42:43] op_sel:[0,0,1] op_sel_hi:[1,0,1] neg_lo:[0,0,1] neg_hi:[0,0,1]
    v_cvt_pk_bf16_f32 v36, v16, v17
    v_cvt_pk_bf16_f32 v37, v18, v19
    v_cvt_pk_bf16_f32 v38, v20, v21
    v_cvt_pk_bf16_f32 v39, v22, v23
    s_and_b32 s42, s3, 15
    v_xor_b32 v28, s42, v0
    s_lshl_b32 s41, s3, 10
    s_add_u32 s41, s41, 114688
    v_lshl_add_u32 v28, v28, 4, s41
    ds_write_b128 v28, v[36:39]
    s_add_u32 s3, s3, 4
    s_add_u32 s44, s44, 1
    s_cmp_lg_u32 s44, 4
    s_cbranch_scc1 S_nf
    s_lshl_b32 s41, s51, 13
    s_add_u32 s41, s41, 4096
    v_lshl_add_u32 v13, v0, 7, s41
    global_load_dword v13, v13, s[32:33] sc1
S_nf:
    s_cmp_lt_u32 s44, s45
    s_cbranch_scc1 S_fl
    s_cmp_eq_u32 s45, 5
    s_cbranch_scc1 A_P2
    s_cmp_eq_u32 s45, 2
    s_cbranch_scc1 H_ret
    s_waitcnt vmcnt(0)
    v_lshrrev_b32 v8, 4, v0
    v_and_b32 v9, 15, v0
    v_lshlrev_b32 v9, 3, v9
    v_lshl_add_u32 v8, v8, 8, v9
    v_add_u32 v8, s98, v8
    ds_read_b64_tr_b16 v[64:65], v8 offset:0
    ds_read_b64_tr_b16 v[66:67], v8 offset:128
    ds_read_b64_tr_b16 v[68:69], v8 offset:4096
    ds_read_b64_tr_b16 v[70:71], v8 offset:4224
    ds_read_b64_tr_b16 v[72:73], v8 offset:1024
    ds_read_b64_tr_b16 v[74:75], v8 offset:1152
    ds_read_b64_tr_b16 v[76:77], v8 offset:5120
    ds_read_b64_tr_b16 v[78:79], v8 offset:5248
    ds_read_b64_tr_b16 v[80:81], v8 offset:2048
    ds_read_b64_tr_b16 v[82:83], v8 offset:2176
    ds_read_b64_tr_b16 v[84:85], v8 offset:6144
    ds_read_b64_tr_b16 v[86:87], v8 offset:6272
    s_waitcnt lgkmcnt(4)
    ds_read_b64_tr_b16 v[88:89], v8 offset:3072
    ds_read_b64_tr_b16 v[90:91], v8 offset:3200
    ds_read_b64_tr_b16 v[92:93], v8 offset:7168
    ds_read_b64_tr_b16 v[94:95], v8 offset:7296
    v_mov_b32 v8, 1
    s_mov_b64 exec, 1
    ds_add_u32 v3, v8 offset:552
    s_mov_b64 exec, -1
    s_mov_b32 s46, 0
W_1:
    ds_read_b32 v8, v3 offset:552
    s_waitcnt lgkmcnt(0)
    v_cmp_gt_u32 vcc, 4, v8
    s_cbranch_vccz Wd_2
    s_add_u32 s46, s46, 1
    s_cmp_lt_u32 s46, 320000
    s_cbranch_scc1 W_1
Wd_2:
    s_setprio 3
    s_branch A_kvp
H_B1:
    s_waitcnt lgkmcnt(0)
    s_barrier
    s_setprio 2
    s_cmp_lg_u32 s35, 7
    s_cbranch_scc1 R_cand
H_fin:
    v_and_b32 v12, 3, v0
    v_lshrrev_b32 v13, 2, v0
    v_lshl_add_u32 v12, v12, 4, v13
    v_and_b32 v13, 1, v0
    v_lshrrev_b32 v14, 1, v0
    v_lshl_add_u32 v13, v13, 4, v14
    v_add_u32 v13, 48, v13
    v_cmp_gt_u32 vcc, 32, v0
    s_lshl_b32 s42, s36, 2
    v_add_u32 v9, s42, v3
    v_cndmask_b32 v12, v13, v12, vcc
    v_lshlrev_b32 v12, 4, v12
    v_add_u32 v12, 147456, v12
    s_mul_i32 s41, s36, 163840
    s_mul_i32 s42, s96, 640
    s_add_u32 s41, s41, s42
    s_add_u32 s41, s41, 196608
    v_lshl_add_u32 v8, v0, 3, s41
    s_mov_b32 s46, 0
W_3:
    ds_read_b32 v11, v9 offset:0
    s_waitcnt lgkmcnt(0)
    v_cmp_gt_u32 vcc, 4, v11
    s_cbranch_vccz Wd_4
    s_add_u32 s46, s46, 1
    s_cmp_lt_u32 s46, 320000
    s_cbranch_scc1 W_3
Wd_4:
    ds_read_b128 v[40:43], v12 offset:0
    ds_read_b128 v[44:47], v12 offset:2048
    ds_read_b128 v[48:51], v12 offset:4096
    ds_read_b128 v[52:55], v12 offset:6144
    s_setprio 3
    s_waitcnt lgkmcnt(2)
    v_pk_add_f32 v[40:41], v[40:41], v[44:45]
    v_pk_add_f32 v[42:43], v[42:43], v[46:47]
    s_waitcnt lgkmcnt(0)
    v_pk_add_f32 v[48:49], v[48:49], v[52:53]
    v_pk_add_f32 v[50:51], v[50:51], v[54:55]
    v_pk_add_f32 v[40:41], v[40:41], v[48:49]
    v_pk_add_f32 v[42:43], v[42:43], v[50:51]
    v_cvt_pk_bf16_f32 v40, v40, v41
    v_cvt_pk_bf16_f32 v41, v42, v43
    s_nop 0
    v_mov_b32_dpp v42, v40 quad_perm:[1,1,3,3] row_mask:0xf bank_mask:0xf
    v_mov_b32_dpp v43, v41 quad_perm:[1,1,3,3] row_mask:0xf bank_mask:0xf
    s_mov_b32 exec_lo, 0x55555555
    s_mov_b32 exec_hi, 0x55555555
    global_store_dwordx4 v8, v[40:43], s[32:33] sc1
    s_mov_b64 exec, -1
    s_setprio 2
    s_cmp_lg_u32 s36, 0
    s_cbranch_scc1 R_cand
    s_waitcnt vmcnt(3)
    s_branch H_P2
R_cand:
    s_lshl_b32 s41, s54, 3
    v_add_u32 v8, s41, v3
    ds_read_b32 v8, v8 offset:16
    s_lshl_b32 s41, s54, 19
    s_lshl_b32 s42, s18, 11
    s_add_u32 s41, s41, s42
    s_add_u32 s41, s41, 524288
    v_lshl_add_u32 v2, v0, 4, s41
    s_waitcnt lgkmcnt(0)
    v_readfirstlane_b32 s41, v8
    s_mov_b32 s55, 0
    s_cmp_lg_u32 s41, s56
    s_cbranch_scc1 R_nocand
    s_mov_b32 s55, 1
    global_store_dwordx4 v2, v[28:31], s[32:33] sc1
    global_store_dwordx4 v2, v[32:35], s[32:33] offset:1024 sc1
R_nocand:
    s_cmp_lg_u32 s54, 0
    s_cbranch_scc1 R_tail
    s_cmp_ge_u32 s35, 4
    s_cbranch_scc1 H_gather
A_P2:
    s_lshl_b32 s42, s36, 2
    v_add_u32 v9, s42, v3
    v_mov_b32 v8, 1
    s_mov_b64 exec, 1
    ds_add_u32 v9, v8 offset:528
    s_mov_b64 exec, -1
    s_mul_i32 s41, s36, 163840
    s_mul_i32 s42, s51, 40960
    s_add_u32 s41, s41, s42
    s_add_u32 s41, s41, 199168
    v_bfe_u32 v14, v0, 3, 2
    v_mul_u32_u24 v14, 640, v14
    v_and_b32 v15, 7, v0
    v_lshl_add_u32 v14, v15, 5, v14
    v_lshrrev_b32 v11, 5, v0
    v_lshl_add_u32 v14, v11, 4, v14
    v_add_u32 v14, s41, v14
    v_and_b32 v15, 31, v0
    v_min_u32 v12, 17, v15
    v_cmp_eq_u32 vcc, 20, v15
    s_nop 1
    v_cndmask_b32 v15, v12, 16, vcc
    v_mul_u32_u24 v11, 640, v11
    v_lshl_add_u32 v15, v15, 4, v11
    s_add_u32 s41, s41, 256
    v_add_u32 v15, s41, v15
    s_mov_b32 s58, 0x65432108
    s_mov_b32 s59, 0x7
    s_lshl_b32 s41, s51, 13
    s_cmp_eq_u32 s36, 0
    s_cselect_b32 s57, 4, 15
    s_cselect_b32 s42, 4096, 0
    s_cselect_b32 s43, 0, 4194304
    s_add_u32 s41, s41, s42
    s_add_u32 s41, s41, s43
    v_lshl_add_u32 v10, v0, 7, s41
    s_and_b32 s97, s100, 4
    s_lshr_b32 s41, s100, 3
    s_and_b32 s41, s41, 3
    s_or_b32 s97, s97, s41
    s_nop 0
    s_mov_b32 s46, 0
    s_cmp_lg_u32 s36, 0
    s_cbranch_scc1 A_nfl
    s_setprio 0
    s_waitcnt vmcnt(0) lgkmcnt(0)
    s_mul_i32 s38, s34, 0x9e3779b1
    s_add_u32 s38, s38, 0x7f4a7c15
    s_sleep 0
    v_cmp_ne_u32 vcc, s38, v13
    s_cbranch_vccz A_nf2
A_flg:
    global_load_dword v8, v10, s[32:33] sc1
    s_waitcnt vmcnt(0)
    v_cmp_ne_u32 vcc, s38, v8
    s_cbranch_vccz A_flgd_5
    s_sleep 2
    s_add_u32 s46, s46, 1
    s_cmp_lt_u32 s46, 40000
    s_cbranch_scc1 A_flg
A_flgd_5:
    s_branch A_nf2
A_nfl:
    s_mov_b32 s46, 0
A_xw:
    ds_read_b32 v12, v9 offset:528
    s_waitcnt lgkmcnt(0)
    v_cmp_gt_u32 vcc, 8, v12
    s_cbranch_vccz A_xwd
    s_sleep 1
    s_add_u32 s46, s46, 1
    s_cmp_lt_u32 s46, 5
    s_cbranch_scc1 A_xw
A_xwd:
    global_load_dword v8, v10, s[32:33] sc1
A_nf2:
    s_xor_b32 s41, s97, 0
    s_mul_i32 s41, s41, 5120
    s_add_u32 s0, s32, s41
    s_addc_u32 s1, s33, 0
    global_load_dwordx4 v[64:67], v14, s[0:1] offset:-2560 sc1
    global_load_dwordx4 v[128:131], v15, s[0:1] offset:-2560 sc1
    global_load_dwordx4 v[132:135], v15, s[0:1] offset:-1280 sc1
    global_load_dwordx4 v[68:71], v14, s[0:1] offset:0 sc1
    global_load_dwordx4 v[136:139], v15, s[0:1] offset:0 sc1
    global_load_dwordx4 v[140:143], v15, s[0:1] offset:1280 sc1
    s_xor_b32 s41, s97, 1
    s_mul_i32 s41, s41, 5120
    s_add_u32 s0, s32, s41
    s_addc_u32 s1, s33, 0
    global_load_dwordx4 v[72:75], v14, s[0:1] offset:-2560 sc1
    global_load_dwordx4 v[144:147], v15, s[0:1] offset:-2560 sc1
    global_load_dwordx4 v[148:151], v15, s[0:1] offset:-1280 sc1
    global_load_dwordx4 v[76:79], v14, s[0:1] offset:0 sc1
    global_load_dwordx4 v[152:155], v15, s[0:1] offset:0 sc1
    global_load_dwordx4 v[156:159], v15, s[0:1] offset:1280 sc1
    s_xor_b32 s41, s97, 2
    s_mul_i32 s41, s41, 5120
    s_add_u32 s0, s32, s41
    s_addc_u32 s1, s33, 0
    global_load_dwordx4 v[80:83], v14, s[0:1] offset:-2560 sc1
    global_load_dwordx4 v[160:163], v15, s[0:1] offset:-2560 sc1
    global_load_dwordx4 v[164:167], v15, s[0:1] offset:-1280 sc1
    global_load_dwordx4 v[84:87], v14, s[0:1] offset:0 sc1
    global_load_dwordx4 v[168:171], v15, s[0:1] offset:0 sc1
    global_load_dwordx4 v[172:175], v15, s[0:1] offset:1280 sc1
    s_mov_b32 s3, 15
    s_cmp_eq_u32 s36, 0
    s_cbranch_scc1 A_go
    s_mov_b32 s46, 0
    s_waitcnt vmcnt(18)
    s_branch A_kc
A_kp:
    s_mov_b64 exec, vcc
    global_load_dword v8, v10, s[32:33] sc1
    s_mov_b64 exec, -1
    s_waitcnt vmcnt(0)
A_kc:
    v_cmp_eq_u32 vcc, -1, v8
    s_cbranch_vccz A_kpd_6
    s_sleep 1
    s_add_u32 s46, s46, 1
    s_cmp_lt_u32 s46, 40000
    s_cbranch_scc1 A_kp
A_kpd_6:
    v_max_u32_dpp v8, v8, v8 row_ror:8 row_mask:0xf bank_mask:0xf
    s_nop 1
    v_max_u32_dpp v8, v8, v8 row_ror:4 row_mask:0xf bank_mask:0xf
    s_nop 1
    v_max_u32_dpp v8, v8, v8 row_ror:2 row_mask:0xf bank_mask:0xf
    s_nop 1
    v_max_u32_dpp v8, v8, v8 row_ror:1 row_mask:0xf bank_mask:0xf
    s_nop 1
    v_max_u32_dpp v8, v8, v8 row_bcast:15 row_mask:0xa bank_mask:0xf
    s_nop 1
    v_max_u32_dpp v8, v8, v8 row_bcast:31 row_mask:0xc bank_mask:0xf
    s_lshl_b32 s41, s54, 4
    s_lshl_b32 s42, s51, 2
    s_add_u32 s41, s41, s42
    v_add_u32 v9, s41, v3
    v_add_u32 v8, 1, v8
    s_mov_b32 exec_lo, 0
    s_mov_b32 exec_hi, 0x80000000
    ds_write_b32 v9, v8 offset:480
    s_mov_b64 exec, -1
    s_lshl_b32 s41, s54, 4
    v_add_u32 v10, s41, v3
    s_mov_b32 s46, 0
K_g_7:
    ds_read_b128 v[16:19], v10 offset:480
    s_waitcnt lgkmcnt(0)
    v_min3_u32 v8, v16, v17, v18
    v_min_u32 v8, v8, v19
    v_cmp_eq_u32 vcc, 0, v8
    s_cbranch_vccz K_gd_8
    s_add_u32 s46, s46, 1
    s_cmp_lt_u32 s46, 320000
    s_cbranch_scc1 K_g_7
K_gd_8:
    v_max3_u32 v8, v16, v17, v18
    v_max_u32 v8, v8, v19
    s_nop 0
    v_readfirstlane_b32 s48, v8
    s_sub_u32 s48, s48, 1
    s_and_b32 s41, s48, 0x7ff
    s_sub_u32 s52, 2047, s41
    s_mov_b32 s101, s52
    s_bfe_u32 s4, s101, 0x20007
    s_lshl_b32 s4, s4, 2
    s_bfe_u32 s42, s52, 0x20001
    s_add_u32 s4, s4, s42
    s_bitcmp1_b32 s52, 0
    s_mov_b32 s5, 0xffff0000
    s_cselect_b32 s5, 0xffff, s5
    s_bitcmp1_b32 s101, 6
    s_cselect_b32 s6, 0, -1
    s_cselect_b32 s7, -1, 0
    s_lshr_b32 s41, s101, 9
    s_bfe_u32 s42, s101, 0x30003
    s_xor_b32 s42, s42, s97
    s_cmp_eq_u32 s41, s51
    s_cselect_b32 s3, s42, 15
    s_xor_b32 s41, s52, s49
    s_lshr_b32 s41, s41, 5
    s_cbranch_scc1 A_go
    s_lshl_b32 s41, s37, 3
    s_sub_u32 s41, s52, s41
    s_sub_u32 s41, s41, 8
    s_bfe_u32 s57, s41, 0x30002
    s_or_b32 s41, s57, 1
    s_max_u32 s41, s41, 4
    s_xor_b32 s42, s41, s57
    s_mov_b32 s43, 0
    s_lshl_b32 s41, s41, 2
    s_add_u32 s41, s41, 4
    s_lshl_b64 s[44:45], s[42:43], s41
    s_xor_b64 s[58:59], s[58:59], s[44:45]
    s_lshl_b32 s41, s57, 2
    s_add_u32 s41, s41, 4
    s_lshl_b64 s[44:45], s[42:43], s41
    s_xor_b64 s[58:59], s[58:59], s[44:45]
A_go:
    s_setprio 0
    s_lshl_b32 s42, s36, 2
    v_add_u32 v9, s42, v3
    v_bfe_u32 v1, v0, 3, 2
    v_mul_u32_u24 v1, 272, v1
    v_and_b32 v2, 7, v0
    v_lshl_add_u32 v1, v2, 5, v1
    v_lshrrev_b32 v2, 5, v0
    v_lshl_add_u32 v1, v2, 4, v1
    v_add_u32 v1, 147456, v1
    s_lshl_b32 s50, s51, 11
    s_add_u32 s50, s50, 1796
    v_mov_b32 v3, 0xdddddddd
    v_and_b32 v0, 31, v0
    s_lshl_b32 s41, s51, 7
    s_add_u32 s41, s41, 156160
    v_lshl_add_u32 v0, v0, 2, s41
    s_mov_b32 s46, 0
    s_waitcnt vmcnt(12)
C_r0:
    v_max3_u32 v12, v64, v68, v128
    v_max3_u32 v13, v132, v136, v140
    v_max_u32 v12, v12, v13
    v_cmp_eq_u32 vcc, -1, v12
    s_cbranch_vccnz C_x0
C_o0:
    s_cmp_eq_u32 s3, 0
    s_cbranch_scc1 C_m0
C_b0:
    s_bfe_u32 s41, s58, 0x40004
    s_and_b32 s43, s41, 4
    s_add_u32 s43, s43, 4
    s_mov_b32 s46, 0
W_9:
    ds_read_b32 v10, v9 offset:536
    s_waitcnt lgkmcnt(0)
    v_cmp_gt_u32 vcc, s43, v10
    s_cbranch_vccz Wd_10
    s_add_u32 s46, s46, 1
    s_cmp_lt_u32 s46, 320000
    s_cbranch_scc1 W_9
Wd_10:
    s_lshl_b32 s2, s36, 2
    s_add_u32 s2, s2, 161304
    s_mul_i32 s41, s41, 1088
    v_add_u32 v8, s41, v1
    ds_read_b128 v[8:11], v8
    s_mov_b32 s46, 0
    v_mov_b64 v[16:17], 0
    v_mov_b64 v[18:19], 0
    v_mov_b64 v[20:21], 0
    v_mov_b64 v[22:23], 0
    v_mov_b64 v[24:25], 0
    s_waitcnt lgkmcnt(0)
    v_mfma_f32_32x32x16_bf16 v[32:47], v[64:67], v[8:11], 0
    s_xor_b32 s41, s97, 3
    s_mul_i32 s41, s41, 5120
    s_add_u32 s0, s32, s41
    s_addc_u32 s1, s33, 0
    s_nop 7
    v_exp_f32 v32, v32
    v_exp_f32 v33, v33
    global_load_dwordx4 v[88:91], v14, s[0:1] offset:-2560 sc1
    v_exp_f32 v34, v34
    v_exp_f32 v35, v35
    v_exp_f32 v36, v36
    v_mfma_f32_32x32x16_bf16 v[48:63], v[68:71], v[8:11], 0
    v_exp_f32 v37, v37
    v_exp_f32 v38, v38
    v_exp_f32 v39, v39
    global_load_dwordx4 v[176:179], v15, s[0:1] offset:-2560 sc1
    v_exp_f32 v40, v40
    v_exp_f32 v41, v41
    v_smfmac_f32_32x32x32_bf16 v[16:31], v[128:131], v[32:39], v3
    v_exp_f32 v42, v42
    v_exp_f32 v43, v43
    v_exp_f32 v44, v44
    global_load_dwordx4 v[180:183], v15, s[0:1] offset:-1280 sc1
    v_exp_f32 v45, v45
    v_exp_f32 v46, v46
    v_exp_f32 v47, v47
    v_exp_f32 v48, v48
    v_exp_f32 v49, v49
    v_smfmac_f32_32x32x32_bf16 v[16:31], v[132:135], v[40:47], v3
    global_load_dwordx4 v[92:95], v14, s[0:1] offset:0 sc1
    v_exp_f32 v50, v50
    v_exp_f32 v51, v51
    v_exp_f32 v52, v52
    s_waitcnt vmcnt(10)
C_r1:
    v_max3_u32 v12, v72, v76, v144
    v_max3_u32 v13, v148, v152, v156
    v_max_u32 v12, v12, v13
    v_cmp_eq_u32 vcc, -1, v12
    s_cbranch_vccnz C_x1
C_o1:
    s_cmp_eq_u32 s3, 1
    s_cbranch_scc1 C_m1
C_b1:
    v_mfma_f32_32x32x16_bf16 v[32:47], v[72:75], v[8:11], 0
    v_exp_f32 v53, v53
    v_exp_f32 v54, v54
    v_exp_f32 v55, v55
    global_load_dwordx4 v[184:187], v15, s[0:1] offset:0 sc1
    v_exp_f32 v56, v56
    v_exp_f32 v57, v57
    v_smfmac_f32_32x32x32_bf16 v[16:31], v[136:139], v[48:55], v3
    v_exp_f32 v58, v58
    v_exp_f32 v59, v59
    v_exp_f32 v60, v60
    global_load_dwordx4 v[188:191], v15, s[0:1] offset:1280 sc1
    v_exp_f32 v61, v61
    v_exp_f32 v62, v62
    v_exp_f32 v63, v63
    s_xor_b32 s41, s97, 4
    s_mul_i32 s41, s41, 5120
    s_add_u32 s0, s32, s41
    s_addc_u32 s1, s33, 0
    v_exp_f32 v32, v32
    v_exp_f32 v33, v33
    v_smfmac_f32_32x32x32_bf16 v[16:31], v[140:143], v[56:63], v3
    global_load_dwordx4 v[96:99], v14, s[0:1] offset:-2560 sc1
    v_exp_f32 v34, v34
    v_exp_f32 v35, v35
    v_exp_f32 v36, v36
    v_mfma_f32_32x32x16_bf16 v[48:63], v[76:79], v[8:11], 0
    v_exp_f32 v37, v37
    v_exp_f32 v38, v38
    v_exp_f32 v39, v39
    global_load_dwordx4 v[192:195], v15, s[0:1] offset:-2560 sc1
    v_exp_f32 v40, v40
    v_exp_f32 v41, v41
    v_smfmac_f32_32x32x32_bf16 v[16:31], v[144:147], v[32:39], v3
    v_exp_f32 v42, v42
    v_exp_f32 v43, v43
    v_exp_f32 v44, v44
    global_load_dwordx4 v[196:199], v15, s[0:1] offset:-1280 sc1
    v_exp_f32 v45, v45
    v_exp_f32 v46, v46
    v_exp_f32 v47, v47
    v_exp_f32 v48, v48
    v_exp_f32 v49, v49
    v_smfmac_f32_32x32x32_bf16 v[16:31], v[148:151], v[40:47], v3
    global_load_dwordx4 v[100:103], v14, s[0:1] offset:0 sc1
    v_exp_f32 v50, v50
    v_exp_f32 v51, v51
    v_exp_f32 v52, v52
    s_waitcnt vmcnt(10)
C_r2:
    v_max3_u32 v12, v80, v84, v160
    v_max3_u32 v13, v164, v168, v172
    v_max_u32 v12, v12, v13
    v_cmp_eq_u32 vcc, -1, v12
    s_cbranch_vccnz C_x2
C_o2:
    s_cmp_eq_u32 s3, 2
    s_cbranch_scc1 C_m2
C_b2:
    v_mfma_f32_32x32x16_bf16 v[32:47], v[80:83], v[8:11], 0
    v_exp_f32 v53, v53
    v_exp_f32 v54, v54
    v_exp_f32 v55, v55
    global_load_dwordx4 v[200:203], v15, s[0:1] offset:0 sc1
    v_exp_f32 v56, v56
    v_exp_f32 v57, v57
    v_smfmac_f32_32x32x32_bf16 v[16:31], v[152:155], v[48:55], v3
    v_exp_f32 v58, v58
    v_exp_f32 v59, v59
    v_exp_f32 v60, v60
    global_load_dwordx4 v[204:207], v15, s[0:1] offset:1280 sc1
    v_exp_f32 v61, v61
    v_exp_f32 v62, v62
    v_exp_f32 v63, v63
    s_xor_b32 s41, s97, 5
    s_mul_i32 s41, s41, 5120
    s_add_u32 s0, s32, s41
    s_addc_u32 s1, s33, 0
    v_exp_f32 v32, v32
    v_exp_f32 v33, v33
    v_smfmac_f32_32x32x32_bf16 v[16:31], v[156:159], v[56:63], v3
    global_load_dwordx4 v[104:107], v14, s[0:1] offset:-2560 sc1
    v_exp_f32 v34, v34
    v_exp_f32 v35, v35
    v_exp_f32 v36, v36
    v_mfma_f32_32x32x16_bf16 v[48:63], v[84:87], v[8:11], 0
    v_exp_f32 v37, v37
    v_exp_f32 v38, v38
    v_exp_f32 v39, v39
    global_load_dwordx4 v[208:211], v15, s[0:1] offset:-2560 sc1
    v_exp_f32 v40, v40
    v_exp_f32 v41, v41
    v_smfmac_f32_32x32x32_bf16 v[16:31], v[160:163], v[32:39], v3
    v_exp_f32 v42, v42
    v_exp_f32 v43, v43
    v_exp_f32 v44, v44
    global_load_dwordx4 v[212:215], v15, s[0:1] offset:-1280 sc1
    v_exp_f32 v45, v45
    v_exp_f32 v46, v46
    v_exp_f32 v47, v47
    v_exp_f32 v48, v48
    v_exp_f32 v49, v49
    v_smfmac_f32_32x32x32_bf16 v[16:31], v[164:167], v[40:47], v3
    global_load_dwordx4 v[108:111], v14, s[0:1] offset:0 sc1
    v_exp_f32 v50, v50
    v_exp_f32 v51, v51
    v_exp_f32 v52, v52
    s_waitcnt vmcnt(10)
C_r3:
    v_max3_u32 v12, v88, v92, v176
    v_max3_u32 v13, v180, v184, v188
    v_max_u32 v12, v12, v13
    v_cmp_eq_u32 vcc, -1, v12
    s_cbranch_vccnz C_x3
C_o3:
    s_cmp_eq_u32 s3, 3
    s_cbranch_scc1 C_m3
C_b3:
    v_mfma_f32_32x32x16_bf16 v[32:47], v[88:91], v[8:11], 0
    v_exp_f32 v53, v53
    v_exp_f32 v54, v54
    v_exp_f32 v55, v55
    global_load_dwordx4 v[216:219], v15, s[0:1] offset:0 sc1
    v_exp_f32 v56, v56
    v_exp_f32 v57, v57
    v_smfmac_f32_32x32x32_bf16 v[16:31], v[168:171], v[48:55], v3
    v_exp_f32 v58, v58
    v_exp_f32 v59, v59
    v_exp_f32 v60, v60
    global_load_dwordx4 v[220:223], v15, s[0:1] offset:1280 sc1
    v_exp_f32 v61, v61
    v_exp_f32 v62, v62
    v_exp_f32 v63, v63
    s_xor_b32 s41, s97, 6
    s_mul_i32 s41, s41, 5120
    s_add_u32 s0, s32, s41
    s_addc_u32 s1, s33, 0
    v_exp_f32 v32, v32
    v_exp_f32 v33, v33
    v_smfmac_f32_32x32x32_bf16 v[16:31], v[172:175], v[56:63], v3
    global_load_dwordx4 v[112:115], v14, s[0:1] offset:-2560 sc1
    v_exp_f32 v34, v34
    v_exp_f32 v35, v35
    v_exp_f32 v36, v36
    v_mfma_f32_32x32x16_bf16 v[48:63], v[92:95], v[8:11], 0
    v_exp_f32 v37, v37
    v_exp_f32 v38, v38
    v_exp_f32 v39, v39
    global_load_dwordx4 v[224:227], v15, s[0:1] offset:-2560 sc1
    v_exp_f32 v40, v40
    v_exp_f32 v41, v41
    v_smfmac_f32_32x32x32_bf16 v[16:31], v[176:179], v[32:39], v3
    v_exp_f32 v42, v42
    v_exp_f32 v43, v43
    v_exp_f32 v44, v44
    global_load_dwordx4 v[228:231], v15, s[0:1] offset:-1280 sc1
    v_exp_f32 v45, v45
    v_exp_f32 v46, v46
    v_exp_f32 v47, v47
    v_exp_f32 v48, v48
    v_exp_f32 v49, v49
    v_smfmac_f32_32x32x32_bf16 v[16:31], v[180:183], v[40:47], v3
    global_load_dwordx4 v[116:119], v14, s[0:1] offset:0 sc1
    v_exp_f32 v50, v50
    v_exp_f32 v51, v51
    v_exp_f32 v52, v52
    s_waitcnt vmcnt(10)
C_r4:
    v_max3_u32 v12, v96, v100, v192
    v_max3_u32 v13, v196, v200, v204
    v_max_u32 v12, v12, v13
    v_cmp_eq_u32 vcc, -1, v12
    s_cbranch_vccnz C_x4
C_o4:
    s_cmp_eq_u32 s3, 4
    s_cbranch_scc1 C_m4
C_b4:
    v_mfma_f32_32x32x16_bf16 v[32:47], v[96:99], v[8:11], 0
    v_exp_f32 v53, v53
    v_exp_f32 v54, v54
    v_exp_f32 v55, v55
    global_load_dwordx4 v[232:235], v15, s[0:1] offset:0 sc1
    v_exp_f32 v56, v56
    v_exp_f32 v57, v57
    v_smfmac_f32_32x32x32_bf16 v[16:31], v[184:187], v[48:55], v3
    v_exp_f32 v58, v58
    v_exp_f32 v59, v59
    v_exp_f32 v60, v60
    global_load_dwordx4 v[236:239], v15, s[0:1] offset:1280 sc1
    v_exp_f32 v61, v61
    v_exp_f32 v62, v62
    v_exp_f32 v63, v63
    s_xor_b32 s41, s97, 7
    s_mul_i32 s41, s41, 5120
    s_add_u32 s0, s32, s41
    s_addc_u32 s1, s33, 0
    v_exp_f32 v32, v32
    v_exp_f32 v33, v33
    v_smfmac_f32_32x32x32_bf16 v[16:31], v[188:191], v[56:63], v3
    global_load_dwordx4 v[120:123], v14, s[0:1] offset:-2560 sc1
    v_exp_f32 v34, v34
    v_exp_f32 v35, v35
    v_exp_f32 v36, v36
    v_mfma_f32_32x32x16_bf16 v[48:63], v[100:103], v[8:11], 0
    v_exp_f32 v37, v37
    v_exp_f32 v38, v38
    v_exp_f32 v39, v39
    global_load_dwordx4 v[240:243], v15, s[0:1] offset:-2560 sc1
    v_exp_f32 v40, v40
    v_exp_f32 v41, v41
    v_smfmac_f32_32x32x32_bf16 v[16:31], v[192:195], v[32:39], v3
    v_exp_f32 v42, v42
    v_exp_f32 v43, v43
    v_exp_f32 v44, v44
    global_load_dwordx4 v[244:247], v15, s[0:1] offset:-1280 sc1
    v_exp_f32 v45, v45
    v_exp_f32 v46, v46
    v_exp_f32 v47, v47
    v_exp_f32 v48, v48
    v_exp_f32 v49, v49
    v_smfmac_f32_32x32x32_bf16 v[16:31], v[196:199], v[40:47], v3
    global_load_dwordx4 v[124:127], v14, s[0:1] offset:0 sc1
    v_exp_f32 v50, v50
    v_exp_f32 v51, v51
    v_exp_f32 v52, v52
    s_waitcnt vmcnt(10)
C_r5:
    v_max3_u32 v12, v104, v108, v208
    v_max3_u32 v13, v212, v216, v220
    v_max_u32 v12, v12, v13
    v_cmp_eq_u32 vcc, -1, v12
    s_cbranch_vccnz C_x5
C_o5:
    s_cmp_eq_u32 s3, 5
    s_cbranch_scc1 C_m5
C_b5:
    v_mfma_f32_32x32x16_bf16 v[32:47], v[104:107], v[8:11], 0
    v_exp_f32 v53, v53
    v_exp_f32 v54, v54
    v_exp_f32 v55, v55
    global_load_dwordx4 v[248:251], v15, s[0:1] offset:0 sc1
    v_exp_f32 v56, v56
    v_exp_f32 v57, v57
    v_smfmac_f32_32x32x32_bf16 v[16:31], v[200:203], v[48:55], v3
    v_exp_f32 v58, v58
    v_exp_f32 v59, v59
    v_exp_f32 v60, v60
    global_load_dwordx4 v[252:255], v15, s[0:1] offset:1280 sc1
    v_exp_f32 v61, v61
    v_exp_f32 v62, v62
    v_exp_f32 v63, v63
    v_mov_b32 v12, 160768
    v_mov_b32 v13, 1
    s_mov_b64 exec, 1
    ds_add_u32 v12, v13 offset:544
    s_mov_b64 exec, -1
    v_exp_f32 v32, v32
    v_exp_f32 v33, v33
    v_smfmac_f32_32x32x32_bf16 v[16:31], v[204:207], v[56:63], v3
    v_exp_f32 v34, v34
    v_exp_f32 v35, v35
    v_exp_f32 v36, v36
    v_mfma_f32_32x32x16_bf16 v[48:63], v[108:111], v[8:11], 0
    v_exp_f32 v37, v37
    v_exp_f32 v38, v38
    v_exp_f32 v39, v39
    v_exp_f32 v40, v40
    v_exp_f32 v41, v41
    v_smfmac_f32_32x32x32_bf16 v[16:31], v[208:211], v[32:39], v3
    v_exp_f32 v42, v42
    v_exp_f32 v43, v43
    v_exp_f32 v44, v44
    v_exp_f32 v45, v45
    v_exp_f32 v46, v46
    v_exp_f32 v47, v47
    v_exp_f32 v48, v48
    v_exp_f32 v49, v49
    v_smfmac_f32_32x32x32_bf16 v[16:31], v[212:215], v[40:47], v3
    v_exp_f32 v50, v50
    v_exp_f32 v51, v51
    v_exp_f32 v52, v52
    s_waitcnt vmcnt(6)
C_r6:
    v_max3_u32 v12, v112, v116, v224
    v_max3_u32 v13, v228, v232, v236
    v_max_u32 v12, v12, v13
    v_cmp_eq_u32 vcc, -1, v12
    s_cbranch_vccnz C_x6
C_o6:
    s_cmp_eq_u32 s3, 6
    s_cbranch_scc1 C_m6
C_b6:
    v_mfma_f32_32x32x16_bf16 v[32:47], v[112:115], v[8:11], 0
    v_exp_f32 v53, v53
    v_exp_f32 v54, v54
    v_exp_f32 v55, v55
    v_exp_f32 v56, v56
    v_exp_f32 v57, v57
    v_smfmac_f32_32x32x32_bf16 v[16:31], v[216:219], v[48:55], v3
    v_exp_f32 v58, v58
    v_exp_f32 v59, v59
    v_exp_f32 v60, v60
    v_exp_f32 v61, v61
    v_exp_f32 v62, v62
    v_exp_f32 v63, v63
    v_exp_f32 v32, v32
    v_exp_f32 v33, v33
    v_smfmac_f32_32x32x32_bf16 v[16:31], v[220:223], v[56:63], v3
    v_exp_f32 v34, v34
    v_exp_f32 v35, v35
    v_exp_f32 v36, v36
    v_mfma_f32_32x32x16_bf16 v[48:63], v[116:119], v[8:11], 0
    v_exp_f32 v37, v37
    v_exp_f32 v38, v38
    v_exp_f32 v39, v39
    v_exp_f32 v40, v40
    v_exp_f32 v41, v41
    v_smfmac_f32_32x32x32_bf16 v[16:31], v[224:227], v[32:39], v3
    v_exp_f32 v42, v42
    v_exp_f32 v43, v43
    v_exp_f32 v44, v44
    v_exp_f32 v45, v45
    v_exp_f32 v46, v46
    v_exp_f32 v47, v47
    v_exp_f32 v48, v48
    v_exp_f32 v49, v49
    v_smfmac_f32_32x32x32_bf16 v[16:31], v[228:231], v[40:47], v3
    v_exp_f32 v50, v50
    v_exp_f32 v51, v51
    v_exp_f32 v52, v52
    s_waitcnt vmcnt(0)
C_r7:
    v_max3_u32 v12, v120, v124, v240
    v_max3_u32 v13, v244, v248, v252
    v_max_u32 v12, v12, v13
    v_cmp_eq_u32 vcc, -1, v12
    s_cbranch_vccnz C_x7
C_o7:
    s_cmp_eq_u32 s3, 7
    s_cbranch_scc1 C_m7
C_b7:
    v_mfma_f32_32x32x16_bf16 v[32:47], v[120:123], v[8:11], 0
    v_mov_b32 v13, s2
    ds_read_b32 v13, v13
    v_exp_f32 v53, v53
    v_exp_f32 v54, v54
    v_exp_f32 v55, v55
    v_exp_f32 v56, v56
    v_exp_f32 v57, v57
    v_smfmac_f32_32x32x32_bf16 v[16:31], v[232:235], v[48:55], v3
    v_exp_f32 v58, v58
    v_exp_f32 v59, v59
    v_exp_f32 v60, v60
    v_exp_f32 v61, v61
    v_exp_f32 v62, v62
    v_exp_f32 v63, v63
    v_exp_f32 v32, v32
    v_exp_f32 v33, v33
    v_smfmac_f32_32x32x32_bf16 v[16:31], v[236:239], v[56:63], v3
    v_exp_f32 v34, v34
    v_exp_f32 v35, v35
    v_exp_f32 v36, v36
    v_mfma_f32_32x32x16_bf16 v[48:63], v[124:127], v[8:11], 0
    s_waitcnt lgkmcnt(0)
    v_cmp_gt_u32 vcc, 8, v13
    s_cbranch_vccnz A_q8
A_q8b:
    s_bfe_u32 s41, s58, 0x40008
    s_mul_i32 s41, s41, 1088
    v_add_u32 v8, s41, v1
    ds_read_b128 v[8:11], v8
    v_exp_f32 v37, v37
    v_exp_f32 v38, v38
    v_exp_f32 v39, v39
    v_exp_f32 v40, v40
    v_exp_f32 v41, v41
    v_smfmac_f32_32x32x32_bf16 v[16:31], v[240:243], v[32:39], v3
    v_exp_f32 v42, v42
    v_exp_f32 v43, v43
    v_exp_f32 v44, v44
    v_exp_f32 v45, v45
    v_exp_f32 v46, v46
    v_exp_f32 v47, v47
    v_exp_f32 v48, v48
    v_exp_f32 v49, v49
    v_smfmac_f32_32x32x32_bf16 v[16:31], v[244:247], v[40:47], v3
    v_exp_f32 v50, v50
    v_exp_f32 v51, v51
    v_exp_f32 v52, v52
    s_waitcnt lgkmcnt(0)
    v_mfma_f32_32x32x16_bf16 v[32:47], v[64:67], v[8:11], 0
    v_exp_f32 v53, v53
    v_exp_f32 v54, v54
    v_exp_f32 v55, v55
    v_exp_f32 v56, v56
    v_exp_f32 v57, v57
    v_smfmac_f32_32x32x32_bf16 v[16:31], v[248:251], v[48:55], v3
    v_exp_f32 v58, v58
    v_exp_f32 v59, v59
    v_exp_f32 v60, v60
    v_exp_f32 v61, v61
    v_exp_f32 v62, v62
    v_exp_f32 v63, v63
    v_mov_b64 v[12:13], 0
    s_lshr_b64 s[58:59], s[58:59], 4
A_pass:
    v_exp_f32 v32, v32
    v_exp_f32 v33, v33
    v_smfmac_f32_32x32x32_bf16 v[16:31], v[252:255], v[56:63], v3
    v_exp_f32 v34, v34
    v_exp_f32 v35, v35
    v_exp_f32 v36, v36
    v_mfma_f32_32x32x16_bf16 v[48:63], v[68:71], v[8:11], 0
    s_and_b32 s41, s58, 15
    s_lshl_b32 s42, s41, 13
    s_add_u32 m0, s42, s50
    v_lshl_add_u32 v2, s41, 9, v0
    v_exp_f32 v37, v37
    v_exp_f32 v38, v38
    v_exp_f32 v39, v39
    v_exp_f32 v40, v40
    ds_write_addtid_b32 v16 offset:63740
    ds_write_addtid_b32 v17 offset:63996
    ds_write_addtid_b32 v18 offset:64252
    ds_write_addtid_b32 v19 offset:64508
    ds_write_addtid_b32 v20 offset:64764
    ds_write_addtid_b32 v21 offset:65020
    ds_write_addtid_b32 v22 offset:65276
    ds_write_addtid_b32 v23 offset:65532
    ds_write_b32 v2, v24
    v_mfma_f32_32x32x8_f16 v[16:31], v[12:13], v[12:13], 0
    v_exp_f32 v41, v41
    v_exp_f32 v42, v42
    v_exp_f32 v43, v43
    v_exp_f32 v44, v44
    v_smfmac_f32_32x32x32_bf16 v[16:31], v[128:131], v[32:39], v3
    v_exp_f32 v45, v45
    v_exp_f32 v46, v46
    v_exp_f32 v47, v47
    v_exp_f32 v48, v48
    v_exp_f32 v49, v49
    v_smfmac_f32_32x32x32_bf16 v[16:31], v[132:135], v[40:47], v3
    v_exp_f32 v50, v50
    v_exp_f32 v51, v51
    v_exp_f32 v52, v52
    v_mfma_f32_32x32x16_bf16 v[32:47], v[72:75], v[8:11], 0
    v_exp_f32 v53, v53
    v_exp_f32 v54, v54
    v_exp_f32 v55, v55
    v_exp_f32 v56, v56
    v_exp_f32 v57, v57
    v_smfmac_f32_32x32x32_bf16 v[16:31], v[136:139], v[48:55], v3
    v_exp_f32 v58, v58
    v_exp_f32 v59, v59
    v_exp_f32 v60, v60
    v_exp_f32 v61, v61
    v_exp_f32 v62, v62
    v_exp_f32 v63, v63
    v_exp_f32 v32, v32
    v_exp_f32 v33, v33
    v_smfmac_f32_32x32x32_bf16 v[16:31], v[140:143], v[56:63], v3
    v_exp_f32 v34, v34
    v_exp_f32 v35, v35
    v_exp_f32 v36, v36
    v_mfma_f32_32x32x16_bf16 v[48:63], v[76:79], v[8:11], 0
    v_exp_f32 v37, v37
    v_exp_f32 v38, v38
    v_exp_f32 v39, v39
    v_exp_f32 v40, v40
    v_exp_f32 v41, v41
    v_smfmac_f32_32x32x32_bf16 v[16:31], v[144:147], v[32:39], v3
    v_exp_f32 v42, v42
    v_exp_f32 v43, v43
    v_exp_f32 v44, v44
    v_exp_f32 v45, v45
    v_exp_f32 v46, v46
    v_exp_f32 v47, v47
    v_exp_f32 v48, v48
    v_exp_f32 v49, v49
    v_smfmac_f32_32x32x32_bf16 v[16:31], v[148:151], v[40:47], v3
    v_exp_f32 v50, v50
    v_exp_f32 v51, v51
    v_exp_f32 v52, v52
    v_mfma_f32_32x32x16_bf16 v[32:47], v[80:83], v[8:11], 0
    v_exp_f32 v53, v53
    v_exp_f32 v54, v54
    v_exp_f32 v55, v55
    v_exp_f32 v56, v56
    v_exp_f32 v57, v57
    v_smfmac_f32_32x32x32_bf16 v[16:31], v[152:155], v[48:55], v3
    v_exp_f32 v58, v58
    v_exp_f32 v59, v59
    v_exp_f32 v60, v60
    v_exp_f32 v61, v61
    v_exp_f32 v62, v62
    v_exp_f32 v63, v63
    v_exp_f32 v32, v32
    v_exp_f32 v33, v33
    v_smfmac_f32_32x32x32_bf16 v[16:31], v[156:159], v[56:63], v3
    v_exp_f32 v34, v34
    v_exp_f32 v35, v35
    v_exp_f32 v36, v36
    v_mfma_f32_32x32x16_bf16 v[48:63], v[84:87], v[8:11], 0
    v_exp_f32 v37, v37
    v_exp_f32 v38, v38
    v_exp_f32 v39, v39
    v_exp_f32 v40, v40
    v_exp_f32 v41, v41
    v_smfmac_f32_32x32x32_bf16 v[16:31], v[160:163], v[32:39], v3
    v_exp_f32 v42, v42
    v_exp_f32 v43, v43
    v_exp_f32 v44, v44
    v_exp_f32 v45, v45
    v_exp_f32 v46, v46
    v_exp_f32 v47, v47
    v_exp_f32 v48, v48
    v_exp_f32 v49, v49
    v_smfmac_f32_32x32x32_bf16 v[16:31], v[164:167], v[40:47], v3
    v_exp_f32 v50, v50
    v_exp_f32 v51, v51
    v_exp_f32 v52, v52
    v_mfma_f32_32x32x16_bf16 v[32:47], v[88:91], v[8:11], 0
    v_exp_f32 v53, v53
    v_exp_f32 v54, v54
    v_exp_f32 v55, v55
    v_exp_f32 v56, v56
    v_exp_f32 v57, v57
    v_smfmac_f32_32x32x32_bf16 v[16:31], v[168:171], v[48:55], v3
    v_exp_f32 v58, v58
    v_exp_f32 v59, v59
    v_exp_f32 v60, v60
    v_exp_f32 v61, v61
    v_exp_f32 v62, v62
    v_exp_f32 v63, v63
    v_exp_f32 v32, v32
    v_exp_f32 v33, v33
    v_smfmac_f32_32x32x32_bf16 v[16:31], v[172:175], v[56:63], v3
    v_exp_f32 v34, v34
    v_exp_f32 v35, v35
    v_exp_f32 v36, v36
    v_mfma_f32_32x32x16_bf16 v[48:63], v[92:95], v[8:11], 0
    v_exp_f32 v37, v37
    v_exp_f32 v38, v38
    v_exp_f32 v39, v39
    v_exp_f32 v40, v40
    v_exp_f32 v41, v41
    v_smfmac_f32_32x32x32_bf16 v[16:31], v[176:179], v[32:39], v3
    v_exp_f32 v42, v42
    v_exp_f32 v43, v43
    v_exp_f32 v44, v44
    v_exp_f32 v45, v45
    v_exp_f32 v46, v46
    v_exp_f32 v47, v47
    v_exp_f32 v48, v48
    v_exp_f32 v49, v49
    v_smfmac_f32_32x32x32_bf16 v[16:31], v[180:183], v[40:47], v3
    v_exp_f32 v50, v50
    v_exp_f32 v51, v51
    v_exp_f32 v52, v52
    v_mfma_f32_32x32x16_bf16 v[32:47], v[96:99], v[8:11], 0
    v_exp_f32 v53, v53
    v_exp_f32 v54, v54
    v_exp_f32 v55, v55
    v_exp_f32 v56, v56
    v_exp_f32 v57, v57
    v_smfmac_f32_32x32x32_bf16 v[16:31], v[184:187], v[48:55], v3
    v_exp_f32 v58, v58
    v_exp_f32 v59, v59
    v_exp_f32 v60, v60
    v_exp_f32 v61, v61
    v_exp_f32 v62, v62
    v_exp_f32 v63, v63
    v_exp_f32 v32, v32
    v_exp_f32 v33, v33
    v_smfmac_f32_32x32x32_bf16 v[16:31], v[188:191], v[56:63], v3
    v_exp_f32 v34, v34
    v_exp_f32 v35, v35
    v_exp_f32 v36, v36
    v_mfma_f32_32x32x16_bf16 v[48:63], v[100:103], v[8:11], 0
    v_exp_f32 v37, v37
    v_exp_f32 v38, v38
    v_exp_f32 v39, v39
    v_exp_f32 v40, v40
    v_exp_f32 v41, v41
    v_smfmac_f32_32x32x32_bf16 v[16:31], v[192:195], v[32:39], v3
    v_exp_f32 v42, v42
    v_exp_f32 v43, v43
    v_exp_f32 v44, v44
    v_exp_f32 v45, v45
    v_exp_f32 v46, v46
    v_exp_f32 v47, v47
    v_exp_f32 v48, v48
    v_exp_f32 v49, v49
    v_smfmac_f32_32x32x32_bf16 v[16:31], v[196:199], v[40:47], v3
    v_exp_f32 v50, v50
    v_exp_f32 v51, v51
    v_exp_f32 v52, v52
    v_mfma_f32_32x32x16_bf16 v[32:47], v[104:107], v[8:11], 0
    v_exp_f32 v53, v53
    v_exp_f32 v54, v54
    v_exp_f32 v55, v55
    v_exp_f32 v56, v56
    v_exp_f32 v57, v57
    v_smfmac_f32_32x32x32_bf16 v[16:31], v[200:203], v[48:55], v3
    v_exp_f32 v58, v58
    v_exp_f32 v59, v59
    v_exp_f32 v60, v60
    v_exp_f32 v61, v61
    v_exp_f32 v62, v62
    v_exp_f32 v63, v63
    v_exp_f32 v32, v32
    v_exp_f32 v33, v33
    v_smfmac_f32_32x32x32_bf16 v[16:31], v[204:207], v[56:63], v3
    v_exp_f32 v34, v34
    v_exp_f32 v35, v35
    v_exp_f32 v36, v36
    v_mfma_f32_32x32x16_bf16 v[48:63], v[108:111], v[8:11], 0
    v_exp_f32 v37, v37
    v_exp_f32 v38, v38
    v_exp_f32 v39, v39
    v_exp_f32 v40, v40
    v_exp_f32 v41, v41
    v_smfmac_f32_32x32x32_bf16 v[16:31], v[208:211], v[32:39], v3
    v_exp_f32 v42, v42
    v_exp_f32 v43, v43
    v_exp_f32 v44, v44
    v_exp_f32 v45, v45
    v_exp_f32 v46, v46
    v_exp_f32 v47, v47
    v_exp_f32 v48, v48
    v_exp_f32 v49, v49
    v_smfmac_f32_32x32x32_bf16 v[16:31], v[212:215], v[40:47], v3
    v_exp_f32 v50, v50
    v_exp_f32 v51, v51
    v_exp_f32 v52, v52
    v_mfma_f32_32x32x16_bf16 v[32:47], v[112:115], v[8:11], 0
    v_exp_f32 v53, v53
    v_exp_f32 v54, v54
    v_exp_f32 v55, v55
    v_exp_f32 v56, v56
    v_exp_f32 v57, v57
    v_smfmac_f32_32x32x32_bf16 v[16:31], v[216:219], v[48:55], v3
    v_exp_f32 v58, v58
    v_exp_f32 v59, v59
    v_exp_f32 v60, v60
    v_exp_f32 v61, v61
    v_exp_f32 v62, v62
    v_exp_f32 v63, v63
    v_exp_f32 v32, v32
    v_exp_f32 v33, v33
    v_smfmac_f32_32x32x32_bf16 v[16:31], v[220:223], v[56:63], v3
    v_exp_f32 v34, v34
    v_exp_f32 v35, v35
    v_exp_f32 v36, v36
    v_mfma_f32_32x32x16_bf16 v[48:63], v[116:119], v[8:11], 0
    v_exp_f32 v37, v37
    v_exp_f32 v38, v38
    v_exp_f32 v39, v39
    v_exp_f32 v40, v40
    v_exp_f32 v41, v41
    v_smfmac_f32_32x32x32_bf16 v[16:31], v[224:227], v[32:39], v3
    v_exp_f32 v42, v42
    v_exp_f32 v43, v43
    v_exp_f32 v44, v44
    v_exp_f32 v45, v45
    v_exp_f32 v46, v46
    v_exp_f32 v47, v47
    v_exp_f32 v48, v48
    v_exp_f32 v49, v49
    v_smfmac_f32_32x32x32_bf16 v[16:31], v[228:231], v[40:47], v3
    v_exp_f32 v50, v50
    v_exp_f32 v51, v51
    v_exp_f32 v52, v52
    v_mfma_f32_32x32x16_bf16 v[32:47], v[120:123], v[8:11], 0
    v_exp_f32 v53, v53
    v_exp_f32 v54, v54
    v_exp_f32 v55, v55
    v_exp_f32 v56, v56
    v_exp_f32 v57, v57
    v_smfmac_f32_32x32x32_bf16 v[16:31], v[232:235], v[48:55], v3
    v_exp_f32 v58, v58
    v_exp_f32 v59, v59
    v_exp_f32 v60, v60
    v_exp_f32 v61, v61
    v_exp_f32 v62, v62
    v_exp_f32 v63, v63
    v_exp_f32 v32, v32
    v_exp_f32 v33, v33
    v_smfmac_f32_32x32x32_bf16 v[16:31], v[236:239], v[56:63], v3
    v_exp_f32 v34, v34
    v_exp_f32 v35, v35
    v_exp_f32 v36, v36
    v_mfma_f32_32x32x16_bf16 v[48:63], v[124:127], v[8:11], 0
    s_bfe_u32 s41, s58, 0x40008
    s_cmp_eq_u32 s41, s57
    s_cbranch_scc1 A_qwait
A_qback:
    s_mul_i32 s41, s41, 1088
    v_add_u32 v8, s41, v1
    ds_read_b128 v[8:11], v8
    v_exp_f32 v37, v37
    v_exp_f32 v38, v38
    v_exp_f32 v39, v39
    v_exp_f32 v40, v40
    v_exp_f32 v41, v41
    v_smfmac_f32_32x32x32_bf16 v[16:31], v[240:243], v[32:39], v3
    v_exp_f32 v42, v42
    v_exp_f32 v43, v43
    v_exp_f32 v44, v44
    v_exp_f32 v45, v45
    v_exp_f32 v46, v46
    v_exp_f32 v47, v47
    v_exp_f32 v48, v48
    v_exp_f32 v49, v49
    v_smfmac_f32_32x32x32_bf16 v[16:31], v[244:247], v[40:47], v3
    v_exp_f32 v50, v50
    v_exp_f32 v51, v51
    v_exp_f32 v52, v52
    s_waitcnt lgkmcnt(0)
    v_mfma_f32_32x32x16_bf16 v[32:47], v[64:67], v[8:11], 0
    v_exp_f32 v53, v53
    v_exp_f32 v54, v54
    v_exp_f32 v55, v55
    v_exp_f32 v56, v56
    v_exp_f32 v57, v57
    v_smfmac_f32_32x32x32_bf16 v[16:31], v[248:251], v[48:55], v3
    v_exp_f32 v58, v58
    v_exp_f32 v59, v59
    v_exp_f32 v60, v60
    v_exp_f32 v61, v61
    v_exp_f32 v62, v62
    v_exp_f32 v63, v63
    s_lshr_b64 s[58:59], s[58:59], 4
    s_cmp_gt_u32 s58, 15
    s_cbranch_scc1 A_pass
    v_smfmac_f32_32x32x32_bf16 v[16:31], v[252:255], v[56:63], v3
    s_branch A_fl
A_qwait:
    v_mov_b32 v14, 160768
    s_lshl_b32 s42, 4, s36
    s_mov_b32 s46, 0
W_11:
    ds_read_b32 v15, v14 offset:516
    s_waitcnt lgkmcnt(0)
    v_cmp_gt_u32 vcc, s42, v15
    s_cbranch_vccz Wd_12
    s_sleep 1
    s_add_u32 s46, s46, 1
    s_cmp_lt_u32 s46, 320000
    s_cbranch_scc1 W_11
Wd_12:
    s_mov_b32 s57, 15
    s_branch A_qback
A_fl:
    s_and_b32 s41, s58, 15
    s_lshl_b32 s42, s41, 13
    s_add_u32 m0, s42, s50
    v_lshl_add_u32 v2, s41, 9, v0
    s_nop 6
    ds_write_addtid_b32 v16 offset:63740
    ds_write_addtid_b32 v17 offset:63996
    ds_write_addtid_b32 v18 offset:64252
    ds_write_addtid_b32 v19 offset:64508
    ds_write_addtid_b32 v20 offset:64764
    ds_write_addtid_b32 v21 offset:65020
    ds_write_addtid_b32 v22 offset:65276
    ds_write_addtid_b32 v23 offset:65532
    ds_write_b32 v2, v24
A_X:
    v_mbcnt_lo_u32_b32 v0, -1, 0
    v_mbcnt_hi_u32_b32 v0, -1, v0
    s_waitcnt lgkmcnt(0)
    s_barrier
    v_mov_b32 v9, 160768
    s_barrier
    ds_read_b32 v9, v9 offset:96
    s_lshl_b32 s98, s51, 13
    s_add_u32 s98, s98, 98816
    s_waitcnt lgkmcnt(0)
    v_cmp_ne_u32 vcc, 0, v9
    s_cbranch_vccnz A_slow
    s_cmp_lg_u32 s36, 0
    s_cbranch_scc1 R_P4
    v_mov_b64 v[28:29], -1
    v_mov_b64 v[30:31], -1
    s_lshl_b32 s41, s51, 10
    s_add_u32 s41, s41, 156160
    v_lshl_add_u32 v2, v0, 4, s41
    ds_write_b128 v2, v[28:31]
R_P4:
    s_mul_i32 s41, s35, 2064
    s_add_u32 s41, s41, 65536
    v_lshl_add_u32 v3, v0, 5, s41
    s_waitcnt lgkmcnt(0)
    s_barrier
    ds_read_b128 v[8:11], v3
    ds_read_b128 v[16:19], v3 offset:16512
    ds_read_b128 v[12:15], v3 offset:16
    ds_read_b128 v[20:23], v3 offset:16528
    s_mov_b32 s54, s36
    s_mov_b32 s19, 0
    v_lshlrev_b32 v2, 4, v0
    v_add_u32 v2, 140800, v2
    ds_read_b128 v[36:39], v2 offset:20992
    s_cmp_lg_u32 s52, s49
    s_cbranch_scc1 R_nx
    ds_read_b128 v[4:7], v2
    s_waitcnt lgkmcnt(0)
R_nx:
    s_lshl_b32 s41, s36, 2
    s_or_b32 s41, s41, s35
    s_cmp_ge_u32 s41, 4
    s_cbranch_scc1 R_nd
    s_lshl_b32 s41, s51, 12
    v_lshl_add_u32 v2, v0, 4, s41
    s_mov_b32 m0, s98
    s_nop 0
    global_load_lds_dwordx4 v2, s[12:13] offset:0
    global_load_lds_dwordx4 v2, s[12:13] offset:1024
    global_load_lds_dwordx4 v2, s[12:13] offset:2048
    global_load_lds_dwordx4 v2, s[12:13] offset:3072
    s_add_u32 m0, s98, 4096
    s_nop 0
    global_load_lds_dwordx4 v2, s[14:15] offset:0
    global_load_lds_dwordx4 v2, s[14:15] offset:1024
    global_load_lds_dwordx4 v2, s[14:15] offset:2048
    global_load_lds_dwordx4 v2, s[14:15] offset:3072
R_nd:
    v_lshlrev_b32 v24, 16, v4
    v_and_b32 v25, 0xffff0000, v4
    v_lshlrev_b32 v26, 16, v5
    v_and_b32 v27, 0xffff0000, v5
    v_lshlrev_b32 v28, 16, v6
    v_and_b32 v29, 0xffff0000, v6
    v_lshlrev_b32 v30, 16, v7
    v_and_b32 v31, 0xffff0000, v7
    s_waitcnt lgkmcnt(0)
    v_pk_add_f32 v[8:9], v[8:9], v[16:17]
    v_pk_add_f32 v[10:11], v[10:11], v[18:19]
    v_pk_add_f32 v[12:13], v[12:13], v[20:21]
    v_pk_add_f32 v[14:15], v[14:15], v[22:23]
    v_pk_add_f32 v[8:9], v[8:9], v[24:25]
    v_pk_add_f32 v[10:11], v[10:11], v[26:27]
    v_pk_add_f32 v[12:13], v[12:13], v[28:29]
    v_pk_add_f32 v[14:15], v[14:15], v[30:31]
    v_readfirstlane_b32 s42, v8
    s_nop 1
    v_pk_add_f32 v[16:17], v[8:9], s[42:43] op_sel_hi:[1,0] neg_lo:[0,1] neg_hi:[0,1]
    v_pk_add_f32 v[18:19], v[10:11], s[42:43] op_sel_hi:[1,0] neg_lo:[0,1] neg_hi:[0,1]
    v_pk_add_f32 v[20:21], v[12:13], s[42:43] op_sel_hi:[1,0] neg_lo:[0,1] neg_hi:[0,1]
    v_pk_add_f32 v[22:23], v[14:15], s[42:43] op_sel_hi:[1,0] neg_lo:[0,1] neg_hi:[0,1]
    v_pk_add_f32 v[24:25], v[16:17], v[18:19]
    v_pk_mul_f32 v[26:27], v[16:17], v[16:17]
    v_pk_add_f32 v[24:25], v[24:25], v[20:21]
    v_pk_fma_f32 v[26:27], v[18:19], v[18:19], v[26:27]
    v_pk_add_f32 v[24:25], v[24:25], v[22:23]
    v_pk_fma_f32 v[26:27], v[20:21], v[20:21], v[26:27]
    v_add_f32 v24, v24, v25
    v_pk_fma_f32 v[26:27], v[22:23], v[22:23], v[26:27]
    v_mul_f32 v24, 0x3b000000, v24
    v_add_f32 v25, v26, v27
    s_nop 0
    v_add_f32_dpp v24, v24, v24 row_ror:8 row_mask:0xf bank_mask:0xf
    v_add_f32_dpp v25, v25, v25 row_ror:8 row_mask:0xf bank_mask:0xf
    s_nop 0
    v_add_f32_dpp v24, v24, v24 row_ror:4 row_mask:0xf bank_mask:0xf
    v_add_f32_dpp v25, v25, v25 row_ror:4 row_mask:0xf bank_mask:0xf
    s_nop 0
    v_add_f32_dpp v24, v24, v24 row_ror:2 row_mask:0xf bank_mask:0xf
    v_add_f32_dpp v25, v25, v25 row_ror:2 row_mask:0xf bank_mask:0xf
    s_nop 0
    v_add_f32_dpp v24, v24, v24 row_ror:1 row_mask:0xf bank_mask:0xf
    v_add_f32_dpp v25, v25, v25 row_ror:1 row_mask:0xf bank_mask:0xf
    s_nop 0
    v_add_f32_dpp v24, v24, v24 row_bcast:15 row_mask:0xa bank_mask:0xf
    v_add_f32_dpp v25, v25, v25 row_bcast:15 row_mask:0xa bank_mask:0xf
    s_nop 0
    v_add_f32_dpp v24, v24, v24 row_bcast:31 row_mask:0xc bank_mask:0xf
    v_add_f32_dpp v25, v25, v25 row_bcast:31 row_mask:0xc bank_mask:0xf
    v_mul_f32 v25, 0x3b000000, v25
    v_fma_f32 v25, -v24, v24, v25
    v_max_f32 v25, 0, v25
    v_add_f32 v25, 0x3727c5ac, v25
    v_rsq_f32 v25, v25
    s_nop 0
    v_mul_f32 v24, v24, v25
    v_readlane_b32 s42, v25, 63
    v_readlane_b32 s43, v24, 63
    s_nop 1
    v_pk_fma_f32 v[16:17], v[16:17], s[42:43], s[42:43] op_sel:[0,0,1] op_sel_hi:[1,0,1] neg_lo:[0,0,1] neg_hi:[0,0,1]
    v_pk_fma_f32 v[18:19], v[18:19], s[42:43], s[42:43] op_sel:[0,0,1] op_sel_hi:[1,0,1] neg_lo:[0,0,1] neg_hi:[0,0,1]
    v_pk_fma_f32 v[20:21], v[20:21], s[42:43], s[42:43] op_sel:[0,0,1] op_sel_hi:[1,0,1] neg_lo:[0,0,1] neg_hi:[0,0,1]
    v_pk_fma_f32 v[22:23], v[22:23], s[42:43], s[42:43] op_sel:[0,0,1] op_sel_hi:[1,0,1] neg_lo:[0,0,1] neg_hi:[0,0,1]
    v_cvt_pk_bf16_f32 v28, v16, v17
    v_cvt_pk_bf16_f32 v29, v18, v19
    v_cvt_pk_bf16_f32 v30, v20, v21
    v_cvt_pk_bf16_f32 v31, v22, v23
    v_dot2_f32_bf16 v1, v28, v36, 0
    v_dot2_f32_bf16 v1, v29, v37, v1
    v_dot2_f32_bf16 v1, v30, v38, v1
    v_dot2_f32_bf16 v1, v31, v39, v1
    s_nop 2
    v_add_f32_dpp v1, v1, v1 row_ror:8 row_mask:0xf bank_mask:0xf
    s_nop 1
    v_add_f32_dpp v1, v1, v1 row_ror:4 row_mask:0xf bank_mask:0xf
    s_nop 1
    v_add_f32_dpp v1, v1, v1 row_ror:2 row_mask:0xf bank_mask:0xf
    s_nop 1
    v_add_f32_dpp v1, v1, v1 row_ror:1 row_mask:0xf bank_mask:0xf
    s_nop 1
    v_add_f32_dpp v1, v1, v1 row_bcast:15 row_mask:0xa bank_mask:0xf
    s_nop 1
    v_add_f32_dpp v1, v1, v1 row_bcast:31 row_mask:0xc bank_mask:0xf
    v_cvt_pk_bf16_f32 v1, 0, v1
    v_ashrrev_i32 v2, 31, v1
    v_or_b32 v2, 0x80000000, v2
    v_xor_b32 v1, v1, v2
    v_and_b32 v1, 0xffff0000, v1
    s_sub_u32 s41, 2047, s49
    v_or_b32 v1, s41, v1
    s_lshl_b32 s41, s54, 3
    s_add_u32 s41, s41, 160784
    v_mov_b32 v3, s41
    v_readlane_b32 s56, v1, 63
    v_mov_b32 v2, 1
    s_mov_b32 exec_lo, 0
    s_mov_b32 exec_hi, 0x80000000
    ds_max_u32 v3, v1
    ds_add_rtn_u32 v2, v3, v2 offset:4
    ds_read_b32 v1, v3
    s_mov_b64 exec, -1
    s_cmp_lg_u32 s36, 0
    s_cbranch_scc1 R_lastl
    v_cvt_pk_bf16_f32 v32, v8, v9
    v_cvt_pk_bf16_f32 v33, v10, v11
    v_cvt_pk_bf16_f32 v34, v12, v13
    v_cvt_pk_bf16_f32 v35, v14, v15
    v_pk_add_f32 v[8:9], v[16:17], v[8:9]
    v_pk_add_f32 v[10:11], v[18:19], v[10:11]
    v_pk_add_f32 v[12:13], v[20:21], v[12:13]
    v_pk_add_f32 v[14:15], v[22:23], v[14:15]
    v_cvt_pk_bf16_f32 v4, v8, v9
    v_cvt_pk_bf16_f32 v5, v10, v11
    v_cvt_pk_bf16_f32 v6, v12, v13
    v_cvt_pk_bf16_f32 v7, v14, v15
    s_mov_b32 s36, 1
    s_lshl_b32 s41, s18, 7
    s_lshl_b32 s42, s54, 15
    s_add_u32 s41, s41, s42
    s_add_u32 s41, s41, 4194304
    v_mov_b32 v3, s41
    s_waitcnt lgkmcnt(0)
    v_readlane_b32 s6, v2, 63
    s_cmp_lg_u32 s6, 7
    s_cbranch_scc1 K_np_13
    s_mov_b32 exec_lo, 0
    s_mov_b32 exec_hi, 0x80000000
    global_store_dword v3, v1, s[32:33] sc1
    s_mov_b64 exec, -1
K_np_13:
    v_mov_b32 v3, 160768
    s_branch R_P1b
R_lastl:
    v_cvt_pk_bf16_f32 v32, v8, v9
    v_cvt_pk_bf16_f32 v33, v10, v11
    v_cvt_pk_bf16_f32 v34, v12, v13
    v_cvt_pk_bf16_f32 v35, v14, v15
    s_lshl_b32 s41, s18, 7
    s_lshl_b32 s42, s54, 15
    s_add_u32 s41, s41, s42
    s_add_u32 s41, s41, 4194304
    v_mov_b32 v3, s41
    s_waitcnt lgkmcnt(0)
    v_readlane_b32 s6, v2, 63
    s_cmp_lg_u32 s6, 7
    s_cbranch_scc1 K_np_14
    s_mov_b32 exec_lo, 0
    s_mov_b32 exec_hi, 0x80000000
    global_store_dword v3, v1, s[32:33] sc1
    s_mov_b64 exec, -1
K_np_14:
    v_mov_b32 v3, 160768
    v_pk_add_f32 v[8:9], v[16:17], v[8:9]
    v_pk_add_f32 v[10:11], v[18:19], v[10:11]
    v_pk_add_f32 v[12:13], v[20:21], v[12:13]
    v_pk_add_f32 v[14:15], v[22:23], v[14:15]
    v_cvt_pk_bf16_f32 v4, v8, v9
    v_cvt_pk_bf16_f32 v5, v10, v11
    v_cvt_pk_bf16_f32 v6, v12, v13
    v_cvt_pk_bf16_f32 v7, v14, v15
    s_barrier
    s_branch R_cand
R_tail:
    s_lshl_b32 s41, s49, 10
    v_lshl_add_u32 v1, v0, 4, s41
    s_cmp_lt_u32 s35, 0
    s_cbranch_scc1 R_noout
    s_cmp_lg_u32 s55, 0
    s_cbranch_scc1 R_noout
    global_store_dwordx4 v1, v[4:7], s[28:29]
R_noout:
    s_cmp_ge_u32 s35, 4
    s_cbranch_scc1 H_FF2
    s_lshl_b32 s42, s54, 15
    s_lshl_b32 s41, s51, 13
    s_add_u32 s42, s42, s41
    s_add_u32 s42, s42, 4194304
    v_lshl_add_u32 v9, v0, 7, s42
    s_mov_b32 s46, 0
    s_mov_b32 s44, 0
    s_mov_b64 vcc, -1
K_p_15:
    s_mov_b64 exec, vcc
    global_load_dword v8, v9, s[32:33] sc1
    s_mov_b64 exec, -1
    s_waitcnt vmcnt(0)
    v_cmp_eq_u32 vcc, -1, v8
    s_cbranch_vccz K_sd
    v_add_u32 v12, 1, v8
    s_nop 1
    v_max_u32_dpp v12, v12, v12 row_ror:8 row_mask:0xf bank_mask:0xf
    s_nop 1
    v_max_u32_dpp v12, v12, v12 row_ror:4 row_mask:0xf bank_mask:0xf
    s_nop 1
    v_max_u32_dpp v12, v12, v12 row_ror:2 row_mask:0xf bank_mask:0xf
    s_nop 1
    v_max_u32_dpp v12, v12, v12 row_ror:1 row_mask:0xf bank_mask:0xf
    s_nop 1
    v_max_u32_dpp v12, v12, v12 row_bcast:15 row_mask:0xa bank_mask:0xf
    s_nop 1
    v_max_u32_dpp v12, v12, v12 row_bcast:31 row_mask:0xc bank_mask:0xf
    s_nop 0
    v_readlane_b32 s41, v12, 63
    s_cmp_eq_u32 s41, s44
    s_cbranch_scc1 K_sn
    s_mov_b32 s44, s41
    s_sub_u32 s41, s41, 1
    s_andn2_b32 s41, 0x7f8, s41
    s_lshl_b32 s41, s41, 8
    s_add_u32 s41, s41, 1048576
    v_lshl_add_u32 v10, v0, 5, s41
    global_load_dword v11, v10, s[32:33] sc1
K_sn:
    s_add_u32 s46, s46, 1
    s_cmp_lt_u32 s46, 40000
    s_cbranch_scc1 K_p_15
K_sd:
    v_max_u32_dpp v8, v8, v8 row_ror:8 row_mask:0xf bank_mask:0xf
    s_nop 1
    v_max_u32_dpp v8, v8, v8 row_ror:4 row_mask:0xf bank_mask:0xf
    s_nop 1
    v_max_u32_dpp v8, v8, v8 row_ror:2 row_mask:0xf bank_mask:0xf
    s_nop 1
    v_max_u32_dpp v8, v8, v8 row_ror:1 row_mask:0xf bank_mask:0xf
    s_nop 1
    v_max_u32_dpp v8, v8, v8 row_bcast:15 row_mask:0xa bank_mask:0xf
    s_nop 1
    v_max_u32_dpp v8, v8, v8 row_bcast:31 row_mask:0xc bank_mask:0xf
    s_lshl_b32 s41, s54, 4
    s_lshl_b32 s42, s51, 2
    s_add_u32 s41, s41, s42
    v_add_u32 v9, s41, v3
    v_add_u32 v8, 1, v8
    s_mov_b32 exec_lo, 0
    s_mov_b32 exec_hi, 0x80000000
    ds_write_b32 v9, v8 offset:480
    s_mov_b64 exec, -1
    s_cmp_eq_u32 s55, 0
    s_cbranch_scc1 L_end
    s_lshl_b32 s41, s54, 4
    v_add_u32 v10, s41, v3
    s_mov_b32 s46, 0
K_g_16:
    ds_read_b128 v[16:19], v10 offset:480
    s_waitcnt lgkmcnt(0)
    v_min3_u32 v8, v16, v17, v18
    v_min_u32 v8, v8, v19
    v_cmp_eq_u32 vcc, 0, v8
    s_cbranch_vccz K_gd_17
    s_sleep 1
    s_add_u32 s46, s46, 1
    s_cmp_lt_u32 s46, 320000
    s_cbranch_scc1 K_g_16
K_gd_17:
    v_max3_u32 v8, v16, v17, v18
    v_max_u32 v8, v8, v19
    s_nop 0
    v_readfirstlane_b32 s48, v8
    s_sub_u32 s48, s48, 1
    s_and_b32 s41, s48, 0x7ff
    s_sub_u32 s52, 2047, s41
    s_cmp_eq_u32 s52, s49
    s_cbranch_scc1 L_end
R_st:
    global_store_dwordx4 v1, v[4:7], s[28:29]
    s_branch L_end
C_x0:
    s_add_u32 s46, s46, 1
    s_cmp_ge_u32 s46, 40000
    s_cbranch_scc1 C_o0
    s_mov_b64 s[98:99], s[0:1]
    s_xor_b32 s41, s97, 0
    s_mul_i32 s41, s41, 5120
    s_add_u32 s0, s32, s41
    s_addc_u32 s1, s33, 0
    global_load_dwordx4 v[64:67], v14, s[0:1] offset:-2560 sc1
    global_load_dwordx4 v[128:131], v15, s[0:1] offset:-2560 sc1
    global_load_dwordx4 v[132:135], v15, s[0:1] offset:-1280 sc1
    global_load_dwordx4 v[68:71], v14, s[0:1] offset:0 sc1
    global_load_dwordx4 v[136:139], v15, s[0:1] offset:0 sc1
    global_load_dwordx4 v[140:143], v15, s[0:1] offset:1280 sc1
    s_mov_b64 s[0:1], s[98:99]
    s_waitcnt vmcnt(0)
    s_branch C_r0
C_m0:
    v_mov_b32 v12, s5
    s_mov_b64 exec, s[6:7]
    s_set_gpr_idx_on s4, gpr_idx(SRC0,DST)
    s_nop 1
    v_and_b32 v128, v128, v12
    s_nop 1
    s_set_gpr_idx_off
    s_mov_b64 exec, -1
    s_nop 1
    s_branch C_b0
C_x1:
    s_add_u32 s46, s46, 1
    s_cmp_ge_u32 s46, 40000
    s_cbranch_scc1 C_o1
    s_mov_b64 s[98:99], s[0:1]
    s_xor_b32 s41, s97, 1
    s_mul_i32 s41, s41, 5120
    s_add_u32 s0, s32, s41
    s_addc_u32 s1, s33, 0
    global_load_dwordx4 v[72:75], v14, s[0:1] offset:-2560 sc1
    global_load_dwordx4 v[144:147], v15, s[0:1] offset:-2560 sc1
    global_load_dwordx4 v[148:151], v15, s[0:1] offset:-1280 sc1
    global_load_dwordx4 v[76:79], v14, s[0:1] offset:0 sc1
    global_load_dwordx4 v[152:155], v15, s[0:1] offset:0 sc1
    global_load_dwordx4 v[156:159], v15, s[0:1] offset:1280 sc1
    s_mov_b64 s[0:1], s[98:99]
    s_waitcnt vmcnt(0)
    s_branch C_r1
C_m1:
    v_mov_b32 v12, s5
    s_mov_b64 exec, s[6:7]
    s_set_gpr_idx_on s4, gpr_idx(SRC0,DST)
    s_nop 1
    v_and_b32 v144, v144, v12
    s_nop 1
    s_set_gpr_idx_off
    s_mov_b64 exec, -1
    s_nop 1
    s_branch C_b1
C_x2:
    s_add_u32 s46, s46, 1
    s_cmp_ge_u32 s46, 40000
    s_cbranch_scc1 C_o2
    s_mov_b64 s[98:99], s[0:1]
    s_xor_b32 s41, s97, 2
    s_mul_i32 s41, s41, 5120
    s_add_u32 s0, s32, s41
    s_addc_u32 s1, s33, 0
    global_load_dwordx4 v[80:83], v14, s[0:1] offset:-2560 sc1
    global_load_dwordx4 v[160:163], v15, s[0:1] offset:-2560 sc1
    global_load_dwordx4 v[164:167], v15, s[0:1] offset:-1280 sc1
    global_load_dwordx4 v[84:87], v14, s[0:1] offset:0 sc1
    global_load_dwordx4 v[168:171], v15, s[0:1] offset:0 sc1
    global_load_dwordx4 v[172:175], v15, s[0:1] offset:1280 sc1
    s_mov_b64 s[0:1], s[98:99]
    s_waitcnt vmcnt(0)
    s_branch C_r2
C_m2:
    v_mov_b32 v12, s5
    s_mov_b64 exec, s[6:7]
    s_set_gpr_idx_on s4, gpr_idx(SRC0,DST)
    s_nop 1
    v_and_b32 v160, v160, v12
    s_nop 1
    s_set_gpr_idx_off
    s_mov_b64 exec, -1
    s_nop 1
    s_branch C_b2
C_x3:
    s_add_u32 s46, s46, 1
    s_cmp_ge_u32 s46, 40000
    s_cbranch_scc1 C_o3
    s_mov_b64 s[98:99], s[0:1]
    s_xor_b32 s41, s97, 3
    s_mul_i32 s41, s41, 5120
    s_add_u32 s0, s32, s41
    s_addc_u32 s1, s33, 0
    global_load_dwordx4 v[88:91], v14, s[0:1] offset:-2560 sc1
    global_load_dwordx4 v[176:179], v15, s[0:1] offset:-2560 sc1
    global_load_dwordx4 v[180:183], v15, s[0:1] offset:-1280 sc1
    global_load_dwordx4 v[92:95], v14, s[0:1] offset:0 sc1
    global_load_dwordx4 v[184:187], v15, s[0:1] offset:0 sc1
    global_load_dwordx4 v[188:191], v15, s[0:1] offset:1280 sc1
    s_mov_b64 s[0:1], s[98:99]
    s_waitcnt vmcnt(0)
    s_branch C_r3
C_m3:
    v_mov_b32 v12, s5
    s_mov_b64 exec, s[6:7]
    s_set_gpr_idx_on s4, gpr_idx(SRC0,DST)
    s_nop 1
    v_and_b32 v176, v176, v12
    s_nop 1
    s_set_gpr_idx_off
    s_mov_b64 exec, -1
    s_nop 1
    s_branch C_b3
C_x4:
    s_add_u32 s46, s46, 1
    s_cmp_ge_u32 s46, 40000
    s_cbranch_scc1 C_o4
    s_mov_b64 s[98:99], s[0:1]
    s_xor_b32 s41, s97, 4
    s_mul_i32 s41, s41, 5120
    s_add_u32 s0, s32, s41
    s_addc_u32 s1, s33, 0
    global_load_dwordx4 v[96:99], v14, s[0:1] offset:-2560 sc1
    global_load_dwordx4 v[192:195], v15, s[0:1] offset:-2560 sc1
    global_load_dwordx4 v[196:199], v15, s[0:1] offset:-1280 sc1
    global_load_dwordx4 v[100:103], v14, s[0:1] offset:0 sc1
    global_load_dwordx4 v[200:203], v15, s[0:1] offset:0 sc1
    global_load_dwordx4 v[204:207], v15, s[0:1] offset:1280 sc1
    s_mov_b64 s[0:1], s[98:99]
    s_waitcnt vmcnt(0)
    s_branch C_r4
C_m4:
    v_mov_b32 v12, s5
    s_mov_b64 exec, s[6:7]
    s_set_gpr_idx_on s4, gpr_idx(SRC0,DST)
    s_nop 1
    v_and_b32 v192, v192, v12
    s_nop 1
    s_set_gpr_idx_off
    s_mov_b64 exec, -1
    s_nop 1
    s_branch C_b4
C_x5:
    s_add_u32 s46, s46, 1
    s_cmp_ge_u32 s46, 40000
    s_cbranch_scc1 C_o5
    s_mov_b64 s[98:99], s[0:1]
    s_xor_b32 s41, s97, 5
    s_mul_i32 s41, s41, 5120
    s_add_u32 s0, s32, s41
    s_addc_u32 s1, s33, 0
    global_load_dwordx4 v[104:107], v14, s[0:1] offset:-2560 sc1
    global_load_dwordx4 v[208:211], v15, s[0:1] offset:-2560 sc1
    global_load_dwordx4 v[212:215], v15, s[0:1] offset:-1280 sc1
    global_load_dwordx4 v[108:111], v14, s[0:1] offset:0 sc1
    global_load_dwordx4 v[216:219], v15, s[0:1] offset:0 sc1
    global_load_dwordx4 v[220:223], v15, s[0:1] offset:1280 sc1
    s_mov_b64 s[0:1], s[98:99]
    s_waitcnt vmcnt(0)
    s_branch C_r5
C_m5:
    v_mov_b32 v12, s5
    s_mov_b64 exec, s[6:7]
    s_set_gpr_idx_on s4, gpr_idx(SRC0,DST)
    s_nop 1
    v_and_b32 v208, v208, v12
    s_nop 1
    s_set_gpr_idx_off
    s_mov_b64 exec, -1
    s_nop 1
    s_branch C_b5
C_x6:
    s_add_u32 s46, s46, 1
    s_cmp_ge_u32 s46, 40000
    s_cbranch_scc1 C_o6
    s_mov_b64 s[98:99], s[0:1]
    s_xor_b32 s41, s97, 6
    s_mul_i32 s41, s41, 5120
    s_add_u32 s0, s32, s41
    s_addc_u32 s1, s33, 0
    global_load_dwordx4 v[112:115], v14, s[0:1] offset:-2560 sc1
    global_load_dwordx4 v[224:227], v15, s[0:1] offset:-2560 sc1
    global_load_dwordx4 v[228:231], v15, s[0:1] offset:-1280 sc1
    global_load_dwordx4 v[116:119], v14, s[0:1] offset:0 sc1
    global_load_dwordx4 v[232:235], v15, s[0:1] offset:0 sc1
    global_load_dwordx4 v[236:239], v15, s[0:1] offset:1280 sc1
    s_mov_b64 s[0:1], s[98:99]
    s_waitcnt vmcnt(0)
    s_branch C_r6
C_m6:
    v_mov_b32 v12, s5
    s_mov_b64 exec, s[6:7]
    s_set_gpr_idx_on s4, gpr_idx(SRC0,DST)
    s_nop 1
    v_and_b32 v224, v224, v12
    s_nop 1
    s_set_gpr_idx_off
    s_mov_b64 exec, -1
    s_nop 1
    s_branch C_b6
C_x7:
    s_add_u32 s46, s46, 1
    s_cmp_ge_u32 s46, 40000
    s_cbranch_scc1 C_o7
    s_mov_b64 s[98:99], s[0:1]
    s_xor_b32 s41, s97, 7
    s_mul_i32 s41, s41, 5120
    s_add_u32 s0, s32, s41
    s_addc_u32 s1, s33, 0
    global_load_dwordx4 v[120:123], v14, s[0:1] offset:-2560 sc1
    global_load_dwordx4 v[240:243], v15, s[0:1] offset:-2560 sc1
    global_load_dwordx4 v[244:247], v15, s[0:1] offset:-1280 sc1
    global_load_dwordx4 v[124:127], v14, s[0:1] offset:0 sc1
    global_load_dwordx4 v[248:251], v15, s[0:1] offset:0 sc1
    global_load_dwordx4 v[252:255], v15, s[0:1] offset:1280 sc1
    s_mov_b64 s[0:1], s[98:99]
    s_waitcnt vmcnt(0)
    s_branch C_r7
C_m7:
    v_mov_b32 v12, s5
    s_mov_b64 exec, s[6:7]
    s_set_gpr_idx_on s4, gpr_idx(SRC0,DST)
    s_nop 1
    v_and_b32 v240, v240, v12
    s_nop 1
    s_set_gpr_idx_off
    s_mov_b64 exec, -1
    s_nop 1
    s_branch C_b7
A_q8:
    v_mov_b32 v12, s2
    s_mov_b32 s46, 0
W_18:
    ds_read_b32 v13, v12 offset:0
    s_waitcnt lgkmcnt(0)
    v_cmp_gt_u32 vcc, 8, v13
    s_cbranch_vccz Wd_19
    s_sleep 1
    s_add_u32 s46, s46, 1
    s_cmp_lt_u32 s46, 320000
    s_cbranch_scc1 W_18
Wd_19:
    s_branch A_q8b
H_stage:
    v_lshrrev_b32 v48, 2, v0
    v_and_b32 v49, 3, v0
    v_lshlrev_b32 v49, 4, v49
    v_lshl_add_u32 v48, v48, 10, v49
    s_lshl_b32 s41, s51, 6
    s_lshl_b32 s42, s37, 8
    s_add_u32 s41, s41, s42
    v_add_u32 v48, s41, v48
    s_lshl_b32 s5, s51, 12
    s_add_u32 s5, s5, 49152
    s_add_u32 s0, s10, 458752
    s_addc_u32 s1, s11, 0
    s_add_u32 m0, s5, 0
    s_nop 0
    global_load_lds_dwordx4 v48, s[0:1]
    s_add_u32 s0, s10, 475136
    s_addc_u32 s1, s11, 0
    s_add_u32 m0, s5, 1024
    s_nop 0
    global_load_lds_dwordx4 v48, s[0:1]
    s_add_u32 s0, s10, 491520
    s_addc_u32 s1, s11, 0
    s_add_u32 m0, s5, 2048
    s_nop 0
    global_load_lds_dwordx4 v48, s[0:1]
    s_add_u32 s0, s10, 507904
    s_addc_u32 s1, s11, 0
    s_add_u32 m0, s5, 3072
    s_nop 0
    global_load_lds_dwordx4 v48, s[0:1]
    v_lshrrev_b32 v49, 4, v0
    v_lshlrev_b32 v50, 1, v49
    v_xor_b32 v50, v50, v0
    v_and_b32 v50, 15, v50
    v_lshlrev_b32 v50, 4, v50
    v_lshl_add_u32 v50, v49, 10, v50
    v_add_u32 v50, s42, v50
    v_xor_b32 v51, 128, v50
    s_lshl_b32 s41, s51, 1
    s_add_u32 s41, s41, 8
    s_lshl_b32 s4, s41, 13
    s_lshl_b32 s41, s41, 15
    s_add_u32 s0, s10, s41
    s_addc_u32 s1, s11, 0
    s_cmp_eq_u32 s51, 3
    s_cbranch_scc1 H_c3
    s_add_u32 m0, s4, 0
    s_nop 0
    global_load_lds_dwordx4 v50, s[0:1]
    s_add_u32 s0, s0, 4096
    s_addc_u32 s1, s1, 0
    s_add_u32 m0, s4, 1024
    s_nop 0
    global_load_lds_dwordx4 v50, s[0:1]
    s_add_u32 s0, s0, 4096
    s_addc_u32 s1, s1, 0
    s_add_u32 m0, s4, 2048
    s_nop 0
    global_load_lds_dwordx4 v51, s[0:1]
    s_add_u32 s0, s0, 4096
    s_addc_u32 s1, s1, 0
    s_add_u32 m0, s4, 3072
    s_nop 0
    global_load_lds_dwordx4 v51, s[0:1]
    s_add_u32 s0, s0, 4096
    s_addc_u32 s1, s1, 0
    s_add_u32 m0, s4, 4096
    s_nop 0
    global_load_lds_dwordx4 v50, s[0:1]
    s_add_u32 s0, s0, 4096
    s_addc_u32 s1, s1, 0
    s_add_u32 m0, s4, 5120
    s_nop 0
    global_load_lds_dwordx4 v50, s[0:1]
    s_add_u32 s0, s0, 4096
    s_addc_u32 s1, s1, 0
    s_add_u32 m0, s4, 6144
    s_nop 0
    global_load_lds_dwordx4 v51, s[0:1]
    s_add_u32 s0, s0, 4096
    s_addc_u32 s1, s1, 0
    s_add_u32 m0, s4, 7168
    s_nop 0
    global_load_lds_dwordx4 v51, s[0:1]
    s_add_u32 s0, s0, 4096
    s_addc_u32 s1, s1, 0
    s_add_u32 m0, s4, 8192
    s_nop 0
    global_load_lds_dwordx4 v50, s[0:1]
    s_add_u32 s0, s0, 4096
    s_addc_u32 s1, s1, 0
    s_add_u32 m0, s4, 9216
    s_nop 0
    global_load_lds_dwordx4 v50, s[0:1]
    s_add_u32 s0, s0, 4096
    s_addc_u32 s1, s1, 0
    s_add_u32 m0, s4, 10240
    s_nop 0
    global_load_lds_dwordx4 v51, s[0:1]
    s_add_u32 s0, s0, 4096
    s_addc_u32 s1, s1, 0
    s_add_u32 m0, s4, 11264
    s_nop 0
    global_load_lds_dwordx4 v51, s[0:1]
    s_add_u32 s0, s0, 4096
    s_addc_u32 s1, s1, 0
    s_add_u32 m0, s4, 12288
    s_nop 0
    global_load_lds_dwordx4 v50, s[0:1]
    s_add_u32 s0, s0, 4096
    s_addc_u32 s1, s1, 0
    s_add_u32 m0, s4, 13312
    s_nop 0
    global_load_lds_dwordx4 v50, s[0:1]
    s_add_u32 s0, s0, 4096
    s_addc_u32 s1, s1, 0
    s_add_u32 m0, s4, 14336
    s_nop 0
    global_load_lds_dwordx4 v51, s[0:1]
    s_add_u32 s0, s0, 4096
    s_addc_u32 s1, s1, 0
    s_add_u32 m0, s4, 15360
    s_nop 0
    global_load_lds_dwordx4 v51, s[0:1]
    s_add_u32 s0, s0, 4096
    s_addc_u32 s1, s1, 0
    s_branch H_c4
H_c3:
    s_setprio 3
    s_lshl_b32 s41, s100, 7
    s_add_u32 s41, s41, 4096
    v_mov_b32 v1, s41
    v_mov_b32 v3, 160768
    s_waitcnt lgkmcnt(0)
    s_mul_i32 s38, s34, 0x9e3779b1
    s_add_u32 s38, s38, 0x7f4a7c15
    v_mov_b32 v2, s38
    s_waitcnt vmcnt(0)
    s_mov_b64 exec, 1
    global_store_dword v1, v2, s[32:33] sc1
    s_mov_b64 exec, -1
    s_setprio 1
H_c4:
    v_lshrrev_b32 v12, 4, v0
    v_bfe_u32 v13, v0, 2, 2
    v_lshl_add_u32 v1, v12, 3, v13
    v_and_b32 v13, 3, v0
    v_lshlrev_b32 v13, 3, v13
    v_lshl_add_u32 v1, v1, 6, v13
    v_add_u32 v1, s5, v1
    v_mov_b32 v3, 160768
    s_waitcnt lgkmcnt(0)
    s_mul_i32 s38, s34, 0x9e3779b1
    s_add_u32 s38, s38, 0x7f4a7c15
    s_waitcnt vmcnt(16)
    ds_read_b64_tr_b16 v[112:113], v1 offset:0
    ds_read_b64_tr_b16 v[114:115], v1 offset:256
    ds_read_b64_tr_b16 v[116:117], v1 offset:32
    ds_read_b64_tr_b16 v[118:119], v1 offset:288
    ds_read_b64_tr_b16 v[120:121], v1 offset:2048
    ds_read_b64_tr_b16 v[122:123], v1 offset:2304
    ds_read_b64_tr_b16 v[124:125], v1 offset:2080
    ds_read_b64_tr_b16 v[126:127], v1 offset:2336
    v_mov_b32 v8, 1
    s_mov_b64 exec, 1
    ds_add_u32 v3, v8 offset:560
    s_mov_b64 exec, -1
    s_cmp_eq_u32 s51, 3
    s_cbranch_scc1 H_c5
    s_lshl_b32 s4, s51, 14
    s_lshl_b32 s41, s51, 16
    s_add_u32 s0, s10, s41
    s_addc_u32 s1, s11, 0
    s_add_u32 m0, s4, 0
    s_nop 0
    global_load_lds_dwordx4 v50, s[0:1]
    s_add_u32 s0, s0, 4096
    s_addc_u32 s1, s1, 0
    s_add_u32 m0, s4, 1024
    s_nop 0
    global_load_lds_dwordx4 v50, s[0:1]
    s_add_u32 s0, s0, 4096
    s_addc_u32 s1, s1, 0
    s_add_u32 m0, s4, 2048
    s_nop 0
    global_load_lds_dwordx4 v51, s[0:1]
    s_add_u32 s0, s0, 4096
    s_addc_u32 s1, s1, 0
    s_add_u32 m0, s4, 3072
    s_nop 0
    global_load_lds_dwordx4 v51, s[0:1]
    s_add_u32 s0, s0, 4096
    s_addc_u32 s1, s1, 0
    s_add_u32 m0, s4, 4096
    s_nop 0
    global_load_lds_dwordx4 v50, s[0:1]
    s_add_u32 s0, s0, 4096
    s_addc_u32 s1, s1, 0
    s_add_u32 m0, s4, 5120
    s_nop 0
    global_load_lds_dwordx4 v50, s[0:1]
    s_add_u32 s0, s0, 4096
    s_addc_u32 s1, s1, 0
    s_add_u32 m0, s4, 6144
    s_nop 0
    global_load_lds_dwordx4 v51, s[0:1]
    s_add_u32 s0, s0, 4096
    s_addc_u32 s1, s1, 0
    s_add_u32 m0, s4, 7168
    s_nop 0
    global_load_lds_dwordx4 v51, s[0:1]
    s_add_u32 s0, s0, 4096
    s_addc_u32 s1, s1, 0
    s_add_u32 m0, s4, 8192
    s_nop 0
    global_load_lds_dwordx4 v50, s[0:1]
    s_add_u32 s0, s0, 4096
    s_addc_u32 s1, s1, 0
    s_add_u32 m0, s4, 9216
    s_nop 0
    global_load_lds_dwordx4 v50, s[0:1]
    s_add_u32 s0, s0, 4096
    s_addc_u32 s1, s1, 0
    s_add_u32 m0, s4, 10240
    s_nop 0
    global_load_lds_dwordx4 v51, s[0:1]
    s_add_u32 s0, s0, 4096
    s_addc_u32 s1, s1, 0
    s_add_u32 m0, s4, 11264
    s_nop 0
    global_load_lds_dwordx4 v51, s[0:1]
    s_add_u32 s0, s0, 4096
    s_addc_u32 s1, s1, 0
    s_add_u32 m0, s4, 12288
    s_nop 0
    global_load_lds_dwordx4 v50, s[0:1]
    s_add_u32 s0, s0, 4096
    s_addc_u32 s1, s1, 0
    s_add_u32 m0, s4, 13312
    s_nop 0
    global_load_lds_dwordx4 v50, s[0:1]
    s_add_u32 s0, s0, 4096
    s_addc_u32 s1, s1, 0
    s_add_u32 m0, s4, 14336
    s_nop 0
    global_load_lds_dwordx4 v51, s[0:1]
    s_add_u32 s0, s0, 4096
    s_addc_u32 s1, s1, 0
    s_add_u32 m0, s4, 15360
    s_nop 0
    global_load_lds_dwordx4 v51, s[0:1]
    s_add_u32 s0, s0, 4096
    s_addc_u32 s1, s1, 0
H_c5:
    s_mov_b32 s46, 0
W_20:
    ds_read_b32 v8, v3 offset:560
    s_waitcnt lgkmcnt(0)
    v_cmp_gt_u32 vcc, 4, v8
    s_cbranch_vccz Wd_21
    s_add_u32 s46, s46, 1
    s_cmp_lt_u32 s46, 320000
    s_cbranch_scc1 W_20
Wd_21:
    s_lshl_b32 s41, s51, 14
    s_add_u32 s41, s41, 196608
    s_add_u32 s0, s10, s41
    s_addc_u32 s1, s11, 0
    s_mov_b32 s4, s5
    s_add_u32 m0, s4, 0
    s_nop 0
    global_load_lds_dwordx4 v50, s[0:1]
    s_add_u32 s0, s0, 4096
    s_addc_u32 s1, s1, 0
    s_add_u32 m0, s4, 1024
    s_nop 0
    global_load_lds_dwordx4 v50, s[0:1]
    s_add_u32 s0, s0, 4096
    s_addc_u32 s1, s1, 0
    s_add_u32 m0, s4, 2048
    s_nop 0
    global_load_lds_dwordx4 v51, s[0:1]
    s_add_u32 s0, s0, 4096
    s_addc_u32 s1, s1, 0
    s_add_u32 m0, s4, 3072
    s_nop 0
    global_load_lds_dwordx4 v51, s[0:1]
    s_add_u32 s0, s0, 4096
    s_addc_u32 s1, s1, 0
    s_add_u32 s44, s51, 16
    s_lshl_b32 s41, s37, 3
    s_add_u32 s41, s41, s44
    s_add_u32 s41, s41, 8
    s_and_b32 s41, s41, 31
    s_andn2_b32 s43, s49, 31
    s_add_u32 s41, s41, s43
    s_lshl_b32 s41, s41, 10
    s_add_u32 s41, s41, 2048
    v_lshl_add_u32 v1, v0, 4, s41
    global_load_dwordx4 v[224:227], v1, s[8:9] offset:-2048
    global_load_dwordx4 v[228:231], v1, s[8:9] offset:2048
    s_cmp_lg_u32 s35, 6
    s_cbranch_scc1 H_st0
    v_lshlrev_b32 v1, 4, v0
    v_add_u32 v1, 161792, v1
    ds_write_b128 v1, v[44:47]
H_st0:
    s_cmp_eq_u32 s35, 7
    s_cbranch_scc1 H_fin
    s_waitcnt vmcnt(2)
    s_setprio 2
    s_branch H_P2
H_gather:
    v_xor_b32 v12, s51, v0
    v_xor_b32 v13, 4, v12
    v_xor_b32 v14, 8, v12
    v_xor_b32 v15, 12, v12
    s_lshl_b32 s41, s51, 10
    s_add_u32 s41, s41, 114688
    v_lshl_add_u32 v12, v12, 4, s41
    v_lshl_add_u32 v13, v13, 4, s41
    v_lshl_add_u32 v14, v14, 4, s41
    v_lshl_add_u32 v15, v15, 4, s41
    s_mov_b32 s46, 0
    s_sleep 8
H_xg:
    v_lshl_add_u32 v8, v0, 4, s3
    v_lshl_add_u32 v9, v0, 4, s4
    v_lshl_add_u32 v10, v0, 4, s5
    global_load_dwordx4 v[40:43], v8, s[32:33] offset:-2048 sc1
    global_load_dwordx4 v[44:47], v8, s[32:33] offset:2048 sc1
    global_load_dwordx4 v[48:51], v9, s[32:33] offset:-2048 sc1
    global_load_dwordx4 v[52:55], v9, s[32:33] offset:2048 sc1
    global_load_dwordx4 v[56:59], v10, s[32:33] offset:-2048 sc1
    global_load_dwordx4 v[60:63], v10, s[32:33] offset:2048 sc1
    s_waitcnt vmcnt(0)
    v_max3_u32 v16, v40, v44, v48
    v_max3_u32 v17, v52, v56, v60
    v_max_u32 v16, v16, v17
    v_cmp_eq_u32 vcc, -1, v16
    s_cbranch_vccz H_xgd_22
    s_add_u32 s46, s46, 1
    s_cmp_lt_u32 s46, 40000
    s_cbranch_scc1 H_xg
H_xgd_22:
    ds_write_b128 v12, v[40:43] offset:0
    ds_write_b128 v13, v[44:47] offset:4096
    ds_write_b128 v14, v[48:51] offset:8192
    ds_write_b128 v15, v[52:55] offset:12288
    ds_write_b128 v12, v[56:59] offset:16384
    ds_write_b128 v13, v[60:63] offset:20480
H_P2:
    s_lshl_b32 s42, s36, 2
    s_add_u32 s42, s42, 160768
    v_mov_b32 v3, s42
    v_mov_b32 v12, 1
    s_mov_b64 exec, 1
    ds_add_u32 v3, v12 offset:528
    s_mov_b64 exec, -1
    v_and_b32 v1, 15, v0
    v_lshrrev_b32 v2, 4, v0
    v_xor_b32 v8, v2, v1
    v_lshlrev_b32 v1, 10, v1
    v_add_u32 v1, 114688, v1
    v_xor_b32 v9, 4, v8
    v_xor_b32 v10, 8, v8
    v_xor_b32 v11, 12, v8
    v_lshl_add_u32 v8, v8, 4, v1
    v_lshl_add_u32 v9, v9, 4, v1
    v_lshl_add_u32 v10, v10, 4, v1
    v_lshl_add_u32 v11, v11, 4, v1
    v_and_b32 v2, 15, v0
    v_mul_u32_u24 v2, 272, v2
    v_lshrrev_b32 v12, 4, v0
    v_lshl_add_u32 v2, v12, 3, v2
    s_lshl_b32 s41, s51, 6
    s_add_u32 s41, s41, 147456
    v_add_u32 v2, s41, v2
    s_mov_b32 s97, 0
    v_lshrrev_b32 v12, 4, v0
    v_bfe_u32 v13, v0, 2, 2
    v_lshl_add_u32 v1, v12, 3, v13
    v_and_b32 v12, 1, v12
    v_lshl_add_u32 v12, v12, 2, v13
    s_lshl_b32 s41, s51, 1
    v_xor_b32 v12, s41, v12
    v_and_b32 v13, 3, v0
    v_lshl_add_u32 v13, v12, 2, v13
    v_lshlrev_b32 v13, 3, v13
    v_lshl_add_u32 v1, v1, 8, v13
    s_cmp_lg_u32 s36, 0
    s_cbranch_scc1 H_q0
    v_mov_b32 v12, 1
    s_mov_b64 exec, 1
    ds_add_u32 v3, v12 offset:560
    s_mov_b64 exec, -1
    s_mov_b32 s46, 0
W_23:
    ds_read_b32 v12, v3 offset:560
    s_waitcnt lgkmcnt(0)
    v_cmp_gt_u32 vcc, 8, v12
    s_cbranch_vccz Wd_24
    s_add_u32 s46, s46, 1
    s_cmp_lt_u32 s46, 320000
    s_cbranch_scc1 W_23
Wd_24:
    v_add_u32 v12, 0x10000, v1
    v_xor_b32 v13, 32, v12
    ds_read_b64_tr_b16 v[64:65], v12 offset:0
    ds_read_b64_tr_b16 v[66:67], v12 offset:1024
    ds_read_b64_tr_b16 v[68:69], v13 offset:0
    ds_read_b64_tr_b16 v[70:71], v13 offset:1024
    ds_read_b64_tr_b16 v[72:73], v12 offset:8192
    ds_read_b64_tr_b16 v[74:75], v12 offset:9216
    ds_read_b64_tr_b16 v[76:77], v13 offset:8192
    ds_read_b64_tr_b16 v[78:79], v13 offset:9216
    ds_read_b64_tr_b16 v[80:81], v12 offset:16384
    ds_read_b64_tr_b16 v[82:83], v12 offset:17408
    ds_read_b64_tr_b16 v[84:85], v13 offset:16384
    ds_read_b64_tr_b16 v[86:87], v13 offset:17408
    s_waitcnt lgkmcnt(4)
    ds_read_b64_tr_b16 v[88:89], v12 offset:24576
    ds_read_b64_tr_b16 v[90:91], v12 offset:25600
    ds_read_b64_tr_b16 v[92:93], v13 offset:24576
    ds_read_b64_tr_b16 v[94:95], v13 offset:25600
    ds_read_b64_tr_b16 v[96:97], v12 offset:32768
    ds_read_b64_tr_b16 v[98:99], v12 offset:33792
    ds_read_b64_tr_b16 v[100:101], v13 offset:32768
    ds_read_b64_tr_b16 v[102:103], v13 offset:33792
    s_waitcnt lgkmcnt(4)
    ds_read_b64_tr_b16 v[104:105], v12 offset:40960
    ds_read_b64_tr_b16 v[106:107], v12 offset:41984
    ds_read_b64_tr_b16 v[108:109], v13 offset:40960
    ds_read_b64_tr_b16 v[110:111], v13 offset:41984
    s_waitcnt lgkmcnt(0)
H_q0:
    s_mov_b32 s46, 0
W_25:
    ds_read_b32 v12, v3 offset:528
    s_waitcnt lgkmcnt(0)
    v_cmp_gt_u32 vcc, 8, v12
    s_cbranch_vccz Wd_26
    s_add_u32 s46, s46, 1
    s_cmp_lt_u32 s46, 320000
    s_cbranch_scc1 W_25
Wd_26:
H_qp:
    ds_read_b128 v[56:59], v10 offset:768
    ds_read_b128 v[20:23], v8 offset:0
    ds_read_b64_tr_b16 v[24:25], v1 offset:0
    ds_read_b64_tr_b16 v[26:27], v1 offset:1024
    v_xor_b32 v30, 32, v1
    ds_read_b64_tr_b16 v[28:29], v30 offset:0
    ds_read_b64_tr_b16 v[30:31], v30 offset:1024
    ds_read_b128 v[60:63], v11 offset:768
    ds_read_b128 v[32:35], v9 offset:0
    ds_read_b64_tr_b16 v[36:37], v1 offset:8192
    ds_read_b64_tr_b16 v[38:39], v1 offset:9216
    v_xor_b32 v42, 32, v1
    ds_read_b64_tr_b16 v[40:41], v42 offset:8192
    ds_read_b64_tr_b16 v[42:43], v42 offset:9216
    s_waitcnt lgkmcnt(11)
    v_mfma_f32_16x16x32_bf16 v[12:15], v[112:115], v[56:59], 0
    v_mfma_f32_16x16x32_bf16 v[16:19], v[116:119], v[56:59], 0
    ds_read_b128 v[56:59], v8 offset:512
    s_waitcnt lgkmcnt(7)
    v_mfma_f32_16x16x32_bf16 v[12:15], v[24:27], v[20:23], v[12:15]
    v_mfma_f32_16x16x32_bf16 v[16:19], v[28:31], v[20:23], v[16:19]
    ds_read_b128 v[44:47], v10 offset:0
    ds_read_b64_tr_b16 v[48:49], v1 offset:16384
    ds_read_b64_tr_b16 v[50:51], v1 offset:17408
    v_xor_b32 v54, 32, v1
    ds_read_b64_tr_b16 v[52:53], v54 offset:16384
    ds_read_b64_tr_b16 v[54:55], v54 offset:17408
    s_waitcnt lgkmcnt(11)
    v_mfma_f32_16x16x32_bf16 v[12:15], v[120:123], v[60:63], v[12:15]
    v_mfma_f32_16x16x32_bf16 v[16:19], v[124:127], v[60:63], v[16:19]
    ds_read_b128 v[60:63], v9 offset:512
    s_waitcnt lgkmcnt(7)
    v_mfma_f32_16x16x32_bf16 v[12:15], v[36:39], v[32:35], v[12:15]
    v_mfma_f32_16x16x32_bf16 v[16:19], v[40:43], v[32:35], v[16:19]
    ds_read_b128 v[20:23], v11 offset:0
    ds_read_b64_tr_b16 v[24:25], v1 offset:24576
    ds_read_b64_tr_b16 v[26:27], v1 offset:25600
    v_xor_b32 v30, 32, v1
    ds_read_b64_tr_b16 v[28:29], v30 offset:24576
    ds_read_b64_tr_b16 v[30:31], v30 offset:25600
    s_waitcnt lgkmcnt(11)
    v_mfma_f32_16x16x32_bf16 v[12:15], v[64:67], v[56:59], v[12:15]
    v_mfma_f32_16x16x32_bf16 v[16:19], v[68:71], v[56:59], v[16:19]
    ds_read_b128 v[56:59], v10 offset:512
    s_waitcnt lgkmcnt(7)
    v_mfma_f32_16x16x32_bf16 v[12:15], v[48:51], v[44:47], v[12:15]
    v_mfma_f32_16x16x32_bf16 v[16:19], v[52:55], v[44:47], v[16:19]
    ds_read_b128 v[32:35], v8 offset:256
    ds_read_b64_tr_b16 v[36:37], v1 offset:32768
    ds_read_b64_tr_b16 v[38:39], v1 offset:33792
    v_xor_b32 v42, 32, v1
    ds_read_b64_tr_b16 v[40:41], v42 offset:32768
    ds_read_b64_tr_b16 v[42:43], v42 offset:33792
    s_waitcnt lgkmcnt(11)
    v_mfma_f32_16x16x32_bf16 v[12:15], v[72:75], v[60:63], v[12:15]
    v_mfma_f32_16x16x32_bf16 v[16:19], v[76:79], v[60:63], v[16:19]
    ds_read_b128 v[60:63], v11 offset:512
    s_waitcnt lgkmcnt(7)
    v_mfma_f32_16x16x32_bf16 v[12:15], v[24:27], v[20:23], v[12:15]
    v_mfma_f32_16x16x32_bf16 v[16:19], v[28:31], v[20:23], v[16:19]
    ds_read_b128 v[44:47], v9 offset:256
    ds_read_b64_tr_b16 v[48:49], v1 offset:40960
    ds_read_b64_tr_b16 v[50:51], v1 offset:41984
    v_xor_b32 v54, 32, v1
    ds_read_b64_tr_b16 v[52:53], v54 offset:40960
    ds_read_b64_tr_b16 v[54:55], v54 offset:41984
    s_waitcnt lgkmcnt(11)
    v_mfma_f32_16x16x32_bf16 v[12:15], v[80:83], v[56:59], v[12:15]
    v_mfma_f32_16x16x32_bf16 v[16:19], v[84:87], v[56:59], v[16:19]
    ds_read_b128 v[56:59], v8 offset:768
    s_waitcnt lgkmcnt(7)
    v_mfma_f32_16x16x32_bf16 v[12:15], v[36:39], v[32:35], v[12:15]
    v_mfma_f32_16x16x32_bf16 v[16:19], v[40:43], v[32:35], v[16:19]
    ds_read_b128 v[20:23], v10 offset:256
    ds_read_b64_tr_b16 v[24:25], v1 offset:49152
    ds_read_b64_tr_b16 v[26:27], v1 offset:50176
    v_xor_b32 v30, 32, v1
    ds_read_b64_tr_b16 v[28:29], v30 offset:49152
    ds_read_b64_tr_b16 v[30:31], v30 offset:50176
    s_waitcnt lgkmcnt(11)
    v_mfma_f32_16x16x32_bf16 v[12:15], v[88:91], v[60:63], v[12:15]
    v_mfma_f32_16x16x32_bf16 v[16:19], v[92:95], v[60:63], v[16:19]
    ds_read_b128 v[60:63], v9 offset:768
    s_waitcnt lgkmcnt(7)
    v_mfma_f32_16x16x32_bf16 v[12:15], v[48:51], v[44:47], v[12:15]
    v_mfma_f32_16x16x32_bf16 v[16:19], v[52:55], v[44:47], v[16:19]
    ds_read_b128 v[32:35], v11 offset:256
    ds_read_b64_tr_b16 v[36:37], v1 offset:57344
    ds_read_b64_tr_b16 v[38:39], v1 offset:58368
    v_xor_b32 v42, 32, v1
    ds_read_b64_tr_b16 v[40:41], v42 offset:57344
    ds_read_b64_tr_b16 v[42:43], v42 offset:58368
    s_waitcnt lgkmcnt(11)
    v_mfma_f32_16x16x32_bf16 v[12:15], v[96:99], v[56:59], v[12:15]
    v_mfma_f32_16x16x32_bf16 v[16:19], v[100:103], v[56:59], v[16:19]
    s_waitcnt lgkmcnt(6)
    v_mfma_f32_16x16x32_bf16 v[12:15], v[24:27], v[20:23], v[12:15]
    v_mfma_f32_16x16x32_bf16 v[16:19], v[28:31], v[20:23], v[16:19]
    s_waitcnt lgkmcnt(5)
    v_mfma_f32_16x16x32_bf16 v[12:15], v[104:107], v[60:63], v[12:15]
    v_mfma_f32_16x16x32_bf16 v[16:19], v[108:111], v[60:63], v[16:19]
    s_waitcnt lgkmcnt(0)
    v_mfma_f32_16x16x32_bf16 v[12:15], v[36:39], v[32:35], v[12:15]
    v_mfma_f32_16x16x32_bf16 v[16:19], v[40:43], v[32:35], v[16:19]
    s_setprio 2
    s_mov_b32 s42, 1052289595
    v_add_u32 v8, 0x4000, v8
    v_add_u32 v9, 0x4000, v9
    v_add_u32 v10, 0x4000, v10
    v_add_u32 v11, 0x4000, v11
    s_nop 0
    v_pk_mul_f32 v[12:13], v[12:13], s[42:43] op_sel_hi:[1,0]
    v_pk_mul_f32 v[14:15], v[14:15], s[42:43] op_sel_hi:[1,0]
    v_pk_mul_f32 v[16:17], v[16:17], s[42:43] op_sel_hi:[1,0]
    v_pk_mul_f32 v[18:19], v[18:19], s[42:43] op_sel_hi:[1,0]
    v_cvt_pk_bf16_f32 v20, v12, v13
    v_cvt_pk_bf16_f32 v21, v14, v15
    v_cvt_pk_bf16_f32 v22, v16, v17
    v_cvt_pk_bf16_f32 v23, v18, v19
    ds_write_b64 v2, v[20:21]
    ds_write_b64 v2, v[22:23] offset:32
    v_mov_b32 v12, 1
    s_mov_b64 exec, 1
    ds_add_u32 v3, v12 offset:536
    s_mov_b64 exec, -1
    s_cmp_eq_u32 s97, 2
    s_cbranch_scc1 H_fx3
    s_cmp_eq_u32 s97, 1
    s_cbranch_scc1 H_qd
    v_add_u32 v2, 4352, v2
    s_mov_b32 s97, 1
    s_cmp_lg_u32 s36, 0
    s_cbranch_scc1 H_q2
    s_setprio 2
    s_mov_b32 s44, 0
    s_mov_b32 s45, 2
    s_add_u32 s3, s51, 16
    s_waitcnt vmcnt(0)
    s_branch S_fl
H_ret:
    v_mov_b32 v12, 1
    s_mov_b64 exec, 1
    ds_add_u32 v3, v12 offset:556
    s_mov_b64 exec, -1
    s_mov_b32 s46, 0
W_27:
    ds_read_b32 v12, v3 offset:556
    s_waitcnt lgkmcnt(0)
    v_cmp_gt_u32 vcc, 4, v12
    s_cbranch_vccz Wd_28
    s_sleep 1
    s_add_u32 s46, s46, 1
    s_cmp_lt_u32 s46, 320000
    s_cbranch_scc1 W_27
Wd_28:
H_q2:
    s_setprio 0
    s_branch H_qp
H_qd:
    s_cmp_eq_u32 s36, 0
    s_cbranch_scc1 H_prep
    v_mov_b32 v3, 160768
    s_branch H_FFN
H_prep:
    s_mov_b32 s46, 0
W_29:
    ds_read_b32 v12, v3 offset:544
    s_waitcnt lgkmcnt(0)
    v_cmp_gt_u32 vcc, 4, v12
    s_cbranch_vccz Wd_30
    s_sleep 4
    s_add_u32 s46, s46, 1
    s_cmp_lt_u32 s46, 320000
    s_cbranch_scc1 W_29
Wd_30:
    s_min_u32 s43, s18, 223
    s_lshl_b32 s43, s43, 2
    s_add_u32 s43, s43, s51
    s_and_b32 s44, s43, 31
    s_lshr_b32 s45, s43, 5
    v_lshrrev_b32 v2, 3, v0
    v_and_b32 v3, 7, v0
    s_mul_i32 s41, s44, 57344
    s_lshl_b32 s42, s45, 7
    s_add_u32 s41, s41, s42
    v_mul_u32_u24 v1, 7168, v2
    v_lshl_add_u32 v1, v3, 4, v1
    v_add_u32 v1, s41, v1
    global_load_dwordx4 v[40:43], v1, s[22:23]
    global_load_dwordx4 v[44:47], v1, s[22:23] offset:3584
    global_load_dwordx4 v[48:51], v1, s[24:25]
    global_load_dwordx4 v[52:55], v1, s[24:25] offset:3584
    s_lshl_b32 s41, s45, 16
    s_lshl_b32 s42, s44, 5
    s_add_u32 s41, s41, s42
    s_add_u32 s41, s41, 4096
    v_lshlrev_b32 v1, 13, v2
    v_lshl_add_u32 v1, v3, 2, v1
    v_add_u32 v1, s41, v1
    global_load_dword v56, v1, s[26:27] offset:-4096
    global_load_dword v60, v1, s[26:27] offset:-3072
    global_load_dword v57, v1, s[26:27] offset:-2048
    global_load_dword v61, v1, s[26:27] offset:-1024
    global_load_dword v58, v1, s[26:27] offset:0
    global_load_dword v62, v1, s[26:27] offset:1024
    global_load_dword v59, v1, s[26:27] offset:2048
    global_load_dword v63, v1, s[26:27] offset:3072
    v_lshrrev_b32 v9, 4, v0
    v_lshlrev_b32 v8, 1, v9
    v_xor_b32 v8, v8, v0
    v_and_b32 v8, 15, v8
    v_lshlrev_b32 v8, 4, v8
    v_lshl_add_u32 v8, v9, 10, v8
    v_bfe_u32 v10, v0, 2, 2
    v_lshl_add_u32 v16, v9, 3, v10
    v_and_b32 v9, 1, v9
    v_lshl_add_u32 v9, v9, 2, v10
    v_and_b32 v10, 3, v0
    v_lshl_add_u32 v10, v9, 2, v10
    v_lshlrev_b32 v10, 3, v10
    v_lshl_add_u32 v16, v16, 8, v10
    v_xor_b32 v9, 128, v8
    s_lshl_b32 s4, s51, 13
    s_add_u32 s4, s4, 98304
    v_add_u32 v16, s4, v16
    s_lshl_b32 s41, s37, 17
    s_lshl_b32 s42, s51, 8
    s_add_u32 s41, s41, s42
    s_add_u32 s0, s16, s41
    s_addc_u32 s1, s17, 0
    v_xor_b32 v17, 32, v16
    v_xor_b32 v18, 64, v16
    v_xor_b32 v19, 96, v16
    v_xor_b32 v20, 128, v16
    v_xor_b32 v21, 160, v16
    v_xor_b32 v22, 192, v16
    v_xor_b32 v23, 224, v16
    s_add_u32 m0, s4, 0
    s_nop 0
    global_load_lds_dwordx4 v8, s[0:1]
    s_add_u32 s0, s0, 4096
    s_addc_u32 s1, s1, 0
    s_add_u32 m0, s4, 1024
    s_nop 0
    global_load_lds_dwordx4 v8, s[0:1]
    s_add_u32 s0, s0, 4096
    s_addc_u32 s1, s1, 0
    s_add_u32 m0, s4, 2048
    s_nop 0
    global_load_lds_dwordx4 v9, s[0:1]
    s_add_u32 s0, s0, 4096
    s_addc_u32 s1, s1, 0
    s_add_u32 m0, s4, 3072
    s_nop 0
    global_load_lds_dwordx4 v9, s[0:1]
    s_add_u32 s0, s0, 4096
    s_addc_u32 s1, s1, 0
    s_add_u32 m0, s4, 4096
    s_nop 0
    global_load_lds_dwordx4 v8, s[0:1]
    s_add_u32 s0, s0, 4096
    s_addc_u32 s1, s1, 0
    s_add_u32 m0, s4, 5120
    s_nop 0
    global_load_lds_dwordx4 v8, s[0:1]
    s_add_u32 s0, s0, 4096
    s_addc_u32 s1, s1, 0
    s_add_u32 m0, s4, 6144
    s_nop 0
    global_load_lds_dwordx4 v9, s[0:1]
    s_add_u32 s0, s0, 4096
    s_addc_u32 s1, s1, 0
    s_add_u32 m0, s4, 7168
    s_nop 0
    global_load_lds_dwordx4 v9, s[0:1]
    s_add_u32 s0, s0, 4096
    s_addc_u32 s1, s1, 0
    s_waitcnt vmcnt(0)
    ds_read_b64_tr_b16 v[128:129], v16 offset:0
    ds_read_b64_tr_b16 v[130:131], v16 offset:1024
    ds_read_b64_tr_b16 v[132:133], v17 offset:0
    ds_read_b64_tr_b16 v[134:135], v17 offset:1024
    ds_read_b64_tr_b16 v[136:137], v18 offset:0
    ds_read_b64_tr_b16 v[138:139], v18 offset:1024
    ds_read_b64_tr_b16 v[140:141], v19 offset:0
    ds_read_b64_tr_b16 v[142:143], v19 offset:1024
    ds_read_b64_tr_b16 v[144:145], v20 offset:0
    ds_read_b64_tr_b16 v[146:147], v20 offset:1024
    ds_read_b64_tr_b16 v[148:149], v21 offset:0
    ds_read_b64_tr_b16 v[150:151], v21 offset:1024
    s_waitcnt lgkmcnt(4)
    ds_read_b64_tr_b16 v[152:153], v22 offset:0
    ds_read_b64_tr_b16 v[154:155], v22 offset:1024
    ds_read_b64_tr_b16 v[156:157], v23 offset:0
    ds_read_b64_tr_b16 v[158:159], v23 offset:1024
    s_waitcnt lgkmcnt(0)
    s_add_u32 m0, s4, 0
    s_nop 0
    global_load_lds_dwordx4 v8, s[0:1]
    s_add_u32 s0, s0, 4096
    s_addc_u32 s1, s1, 0
    s_add_u32 m0, s4, 1024
    s_nop 0
    global_load_lds_dwordx4 v8, s[0:1]
    s_add_u32 s0, s0, 4096
    s_addc_u32 s1, s1, 0
    s_add_u32 m0, s4, 2048
    s_nop 0
    global_load_lds_dwordx4 v9, s[0:1]
    s_add_u32 s0, s0, 4096
    s_addc_u32 s1, s1, 0
    s_add_u32 m0, s4, 3072
    s_nop 0
    global_load_lds_dwordx4 v9, s[0:1]
    s_add_u32 s0, s0, 4096
    s_addc_u32 s1, s1, 0
    s_add_u32 m0, s4, 4096
    s_nop 0
    global_load_lds_dwordx4 v8, s[0:1]
    s_add_u32 s0, s0, 4096
    s_addc_u32 s1, s1, 0
    s_add_u32 m0, s4, 5120
    s_nop 0
    global_load_lds_dwordx4 v8, s[0:1]
    s_add_u32 s0, s0, 4096
    s_addc_u32 s1, s1, 0
    s_add_u32 m0, s4, 6144
    s_nop 0
    global_load_lds_dwordx4 v9, s[0:1]
    s_add_u32 s0, s0, 4096
    s_addc_u32 s1, s1, 0
    s_add_u32 m0, s4, 7168
    s_nop 0
    global_load_lds_dwordx4 v9, s[0:1]
    s_add_u32 s0, s0, 4096
    s_addc_u32 s1, s1, 0
    s_waitcnt vmcnt(0)
    ds_read_b64_tr_b16 v[160:161], v16 offset:0
    ds_read_b64_tr_b16 v[162:163], v16 offset:1024
    ds_read_b64_tr_b16 v[164:165], v17 offset:0
    ds_read_b64_tr_b16 v[166:167], v17 offset:1024
    ds_read_b64_tr_b16 v[168:169], v18 offset:0
    ds_read_b64_tr_b16 v[170:171], v18 offset:1024
    ds_read_b64_tr_b16 v[172:173], v19 offset:0
    ds_read_b64_tr_b16 v[174:175], v19 offset:1024
    ds_read_b64_tr_b16 v[176:177], v20 offset:0
    ds_read_b64_tr_b16 v[178:179], v20 offset:1024
    ds_read_b64_tr_b16 v[180:181], v21 offset:0
    ds_read_b64_tr_b16 v[182:183], v21 offset:1024
    s_waitcnt lgkmcnt(4)
    ds_read_b64_tr_b16 v[184:185], v22 offset:0
    ds_read_b64_tr_b16 v[186:187], v22 offset:1024
    ds_read_b64_tr_b16 v[188:189], v23 offset:0
    ds_read_b64_tr_b16 v[190:191], v23 offset:1024
    s_waitcnt lgkmcnt(0)
    s_add_u32 m0, s4, 0
    s_nop 0
    global_load_lds_dwordx4 v8, s[0:1]
    s_add_u32 s0, s0, 4096
    s_addc_u32 s1, s1, 0
    s_add_u32 m0, s4, 1024
    s_nop 0
    global_load_lds_dwordx4 v8, s[0:1]
    s_add_u32 s0, s0, 4096
    s_addc_u32 s1, s1, 0
    s_add_u32 m0, s4, 2048
    s_nop 0
    global_load_lds_dwordx4 v9, s[0:1]
    s_add_u32 s0, s0, 4096
    s_addc_u32 s1, s1, 0
    s_add_u32 m0, s4, 3072
    s_nop 0
    global_load_lds_dwordx4 v9, s[0:1]
    s_add_u32 s0, s0, 4096
    s_addc_u32 s1, s1, 0
    s_add_u32 m0, s4, 4096
    s_nop 0
    global_load_lds_dwordx4 v8, s[0:1]
    s_add_u32 s0, s0, 4096
    s_addc_u32 s1, s1, 0
    s_add_u32 m0, s4, 5120
    s_nop 0
    global_load_lds_dwordx4 v8, s[0:1]
    s_add_u32 s0, s0, 4096
    s_addc_u32 s1, s1, 0
    s_add_u32 m0, s4, 6144
    s_nop 0
    global_load_lds_dwordx4 v9, s[0:1]
    s_add_u32 s0, s0, 4096
    s_addc_u32 s1, s1, 0
    s_add_u32 m0, s4, 7168
    s_nop 0
    global_load_lds_dwordx4 v9, s[0:1]
    s_add_u32 s0, s0, 4096
    s_addc_u32 s1, s1, 0
    s_waitcnt vmcnt(0)
    ds_read_b64_tr_b16 v[192:193], v16 offset:0
    ds_read_b64_tr_b16 v[194:195], v16 offset:1024
    ds_read_b64_tr_b16 v[196:197], v17 offset:0
    ds_read_b64_tr_b16 v[198:199], v17 offset:1024
    ds_read_b64_tr_b16 v[200:201], v18 offset:0
    ds_read_b64_tr_b16 v[202:203], v18 offset:1024
    ds_read_b64_tr_b16 v[204:205], v19 offset:0
    ds_read_b64_tr_b16 v[206:207], v19 offset:1024
    ds_read_b64_tr_b16 v[208:209], v20 offset:0
    ds_read_b64_tr_b16 v[210:211], v20 offset:1024
    ds_read_b64_tr_b16 v[212:213], v21 offset:0
    ds_read_b64_tr_b16 v[214:215], v21 offset:1024
    s_waitcnt lgkmcnt(4)
    ds_read_b64_tr_b16 v[216:217], v22 offset:0
    ds_read_b64_tr_b16 v[218:219], v22 offset:1024
    ds_read_b64_tr_b16 v[220:221], v23 offset:0
    ds_read_b64_tr_b16 v[222:223], v23 offset:1024
    s_waitcnt lgkmcnt(0)
    s_add_u32 m0, s4, 0
    s_nop 0
    global_load_lds_dwordx4 v8, s[0:1]
    s_add_u32 s0, s0, 4096
    s_addc_u32 s1, s1, 0
    s_add_u32 m0, s4, 1024
    s_nop 0
    global_load_lds_dwordx4 v8, s[0:1]
    s_add_u32 s0, s0, 4096
    s_addc_u32 s1, s1, 0
    s_add_u32 m0, s4, 2048
    s_nop 0
    global_load_lds_dwordx4 v9, s[0:1]
    s_add_u32 s0, s0, 4096
    s_addc_u32 s1, s1, 0
    s_add_u32 m0, s4, 3072
    s_nop 0
    global_load_lds_dwordx4 v9, s[0:1]
    s_add_u32 s0, s0, 4096
    s_addc_u32 s1, s1, 0
    s_add_u32 m0, s4, 4096
    s_nop 0
    global_load_lds_dwordx4 v8, s[0:1]
    s_add_u32 s0, s0, 4096
    s_addc_u32 s1, s1, 0
    s_add_u32 m0, s4, 5120
    s_nop 0
    global_load_lds_dwordx4 v8, s[0:1]
    s_add_u32 s0, s0, 4096
    s_addc_u32 s1, s1, 0
    s_add_u32 m0, s4, 6144
    s_nop 0
    global_load_lds_dwordx4 v9, s[0:1]
    s_add_u32 s0, s0, 4096
    s_addc_u32 s1, s1, 0
    s_add_u32 m0, s4, 7168
    s_nop 0
    global_load_lds_dwordx4 v9, s[0:1]
    s_add_u32 s0, s0, 4096
    s_addc_u32 s1, s1, 0
    s_waitcnt vmcnt(0)
    ds_read_b64_tr_b16 v[224:225], v16 offset:0
    ds_read_b64_tr_b16 v[226:227], v16 offset:1024
    ds_read_b64_tr_b16 v[228:229], v17 offset:0
    ds_read_b64_tr_b16 v[230:231], v17 offset:1024
    ds_read_b64_tr_b16 v[232:233], v18 offset:0
    ds_read_b64_tr_b16 v[234:235], v18 offset:1024
    ds_read_b64_tr_b16 v[236:237], v19 offset:0
    ds_read_b64_tr_b16 v[238:239], v19 offset:1024
    ds_read_b64_tr_b16 v[240:241], v20 offset:0
    ds_read_b64_tr_b16 v[242:243], v20 offset:1024
    ds_read_b64_tr_b16 v[244:245], v21 offset:0
    ds_read_b64_tr_b16 v[246:247], v21 offset:1024
    s_waitcnt lgkmcnt(4)
    ds_read_b64_tr_b16 v[248:249], v22 offset:0
    ds_read_b64_tr_b16 v[250:251], v22 offset:1024
    ds_read_b64_tr_b16 v[252:253], v23 offset:0
    ds_read_b64_tr_b16 v[254:255], v23 offset:1024
    s_waitcnt lgkmcnt(0)
    v_mov_b32 v1, 160768
    v_mov_b32 v8, 1
    s_mov_b64 exec, 1
    ds_add_u32 v1, v8 offset:516
    s_mov_b64 exec, -1
    v_mov_b64 v[8:9], -1
    v_mov_b64 v[10:11], -1
    s_lshl_b32 s41, s18, 13
    s_lshl_b32 s42, s51, 11
    s_add_u32 s41, s41, s42
    s_add_u32 s41, s41, 2097152
    v_lshl_add_u32 v1, v0, 4, s41
    global_store_dwordx4 v1, v[8:11], s[32:33] sc1
    global_store_dwordx4 v1, v[8:11], s[32:33] offset:1024 sc1
    s_lshr_b32 s41, s51, 1
    s_lshl_b32 s41, s41, 19
    s_and_b32 s42, s51, 1
    s_lshl_b32 s42, s42, 10
    s_add_u32 s41, s41, s42
    s_lshl_b32 s42, s18, 11
    s_add_u32 s41, s41, s42
    s_add_u32 s41, s41, 524288
    v_lshl_add_u32 v1, v0, 4, s41
    global_store_dwordx4 v1, v[8:11], s[32:33] sc1
    s_cmp_ge_u32 s18, 224
    s_cbranch_scc1 H_bursts
    s_setprio 0
    v_perm_b32 v12, v44, v40, s39
    v_perm_b32 v44, v44, v40, s40
    v_mov_b32 v40, v12
    v_perm_b32 v12, v45, v41, s39
    v_perm_b32 v45, v45, v41, s40
    v_mov_b32 v41, v12
    v_perm_b32 v12, v46, v42, s39
    v_perm_b32 v46, v46, v42, s40
    v_mov_b32 v42, v12
    v_perm_b32 v12, v47, v43, s39
    v_perm_b32 v47, v47, v43, s40
    v_mov_b32 v43, v12
    v_perm_b32 v12, v52, v48, s39
    v_perm_b32 v52, v52, v48, s40
    v_mov_b32 v48, v12
    v_perm_b32 v12, v53, v49, s39
    v_perm_b32 v53, v53, v49, s40
    v_mov_b32 v49, v12
    v_perm_b32 v12, v54, v50, s39
    v_perm_b32 v54, v54, v50, s40
    v_mov_b32 v50, v12
    v_perm_b32 v12, v55, v51, s39
    v_perm_b32 v55, v55, v51, s40
    v_mov_b32 v51, v12
    v_perm_b32 v12, v60, v56, s39
    v_perm_b32 v60, v60, v56, s40
    v_mov_b32 v56, v12
    v_perm_b32 v12, v61, v57, s39
    v_perm_b32 v61, v61, v57, s40
    v_mov_b32 v57, v12
    v_perm_b32 v12, v62, v58, s39
    v_perm_b32 v62, v62, v58, s40
    v_mov_b32 v58, v12
    v_perm_b32 v12, v63, v59, s39
    v_perm_b32 v63, v63, v59, s40
    v_mov_b32 v59, v12
    s_setprio 2
    v_lshlrev_b32 v2, 4, v2
    v_lshl_add_u32 v2, v3, 15, v2
    s_lshl_b32 s41, s45, 18
    s_lshr_b32 s42, s44, 3
    s_lshl_b32 s42, s42, 13
    s_add_u32 s41, s41, s42
    s_and_b32 s42, s44, 7
    s_lshl_b32 s42, s42, 7
    s_add_u32 s41, s41, s42
    s_add_u32 s41, s41, 33554432
    v_add_u32 v1, s41, v2
    global_store_dwordx4 v1, v[40:43], s[32:33] offset:0 sc1
    global_store_dwordx4 v1, v[44:47], s[32:33] offset:1024 sc1
    global_store_dwordx4 v1, v[48:51], s[32:33] offset:2048 sc1
    global_store_dwordx4 v1, v[52:55], s[32:33] offset:3072 sc1
    s_lshl_b32 s41, s44, 18
    s_lshr_b32 s42, s45, 3
    s_lshl_b32 s42, s42, 13
    s_add_u32 s41, s41, s42
    s_and_b32 s42, s45, 7
    s_lshl_b32 s42, s42, 7
    s_add_u32 s41, s41, s42
    s_add_u32 s41, s41, 33558528
    v_add_u32 v1, s41, v2
    global_store_dwordx4 v1, v[56:59], s[32:33] offset:0 sc1
    global_store_dwordx4 v1, v[60:63], s[32:33] offset:1024 sc1
H_bursts:
    s_lshr_b32 s41, s51, 1
    s_and_b32 s42, s51, 1
    s_lshl_b32 s44, s41, 13
    s_lshl_b32 s43, s42, 10
    s_add_u32 s44, s44, s43
    s_add_u32 s44, s44, 65536
    s_lshl_b32 s45, s41, 9
    s_add_u32 s45, s45, 156160
    v_bfe_u32 v3, v0, 3, 2
    v_mul_u32_u24 v3, 272, v3
    v_and_b32 v8, 7, v0
    v_lshl_add_u32 v3, v8, 5, v3
    s_mul_i32 s43, s41, 1088
    s_add_u32 s43, s43, 131072
    v_add_u32 v3, s43, v3
    v_and_b32 v2, 15, v0
    v_mul_u32_u24 v2, 272, v2
    v_lshrrev_b32 v8, 4, v0
    v_lshl_add_u32 v2, v8, 4, v2
    v_add_u32 v2, 131072, v2
    s_mul_i32 s50, s36, 12582912
    s_mov_b32 s98, 0x00ff00ff
    s_mov_b32 s99, 0x00ff00ff
    s_mul_i32 s41, s51, 12288
    s_add_u32 s50, s50, s41
    s_add_u32 s50, s50, 6291456
    s_add_u32 s53, s38, s36
    s_add_u32 s53, s53, 1
    s_add_u32 s41, s37, 3
    s_and_b32 s41, s41, 3
    s_andn2_b32 s43, s18, 3
    s_add_u32 s41, s41, s43
    s_mul_i32 s41, s41, 49152
    s_add_u32 s41, s41, s50
    s_add_u32 s41, s41, 8192
    v_lshl_add_u32 v24, v0, 4, s41
    v_mov_b64 v[8:9], -1
    v_mov_b64 v[10:11], -1
    global_store_dwordx4 v24, v[8:11], s[32:33] offset:0 sc1
    global_store_dwordx4 v24, v[8:11], s[32:33] offset:1024 sc1
    global_store_dwordx4 v24, v[8:11], s[32:33] offset:2048 sc1
    global_store_dwordx4 v24, v[8:11], s[32:33] offset:3072 sc1
    s_andn2_b32 s41, s36, s19
    s_cbranch_scc0 H_c0_31
    v_lshrrev_b32 v28, 5, v0
    s_lshl_b32 s41, s51, 5
    s_add_u32 s41, s41, 142336
    v_lshl_add_u32 v28, v28, 4, s41
    ds_read_b128 v[8:11], v3 offset:16384
    ds_read_b128 v[12:15], v3 offset:16400
    ds_read_b128 v[28:31], v28
    s_waitcnt lgkmcnt(1)
    v_dot2_f32_bf16 v1, v8, s0, 0
    s_nop 2
    v_dot2_f32_bf16 v1, v9, s1, v1
    v_dot2_f32_bf16 v1, v10, s2, v1
    v_dot2_f32_bf16 v1, v11, s3, v1
    v_dot2_f32_bf16 v1, v12, s4, v1
    v_dot2_f32_bf16 v1, v13, s5, v1
    v_dot2_f32_bf16 v1, v14, s6, v1
    v_dot2_f32_bf16 v1, v15, s7, v1
    s_nop 2
    v_exp_f32 v1, v1
    s_waitcnt lgkmcnt(0)
    v_and_b32 v1, 0xffff0000, v1
    v_pk_mul_f32 v[28:29], v[28:29], v[0:1] op_sel:[0,1] op_sel_hi:[1,1]
    v_pk_mul_f32 v[30:31], v[30:31], v[0:1] op_sel:[0,1] op_sel_hi:[1,1]
    s_branch H_c1_32
H_c0_31:
    v_mov_b32 v1, 0
    v_mov_b64 v[28:29], 0
    v_mov_b64 v[30:31], 0
H_c1_32:
    v_and_b32 v10, 31, v0
    s_add_u32 s41, s45, 0
    v_lshl_add_u32 v10, v10, 2, s41
    v_lshl_add_u32 v26, v0, 2, s44
    v_lshl_add_u32 v13, v0, 3, s45
    s_mov_b32 s46, 0
H_lw_33:
    ds_read_b32 v8, v13 offset:0
    s_waitcnt lgkmcnt(0)
    v_cmp_eq_u32 vcc, -1, v8
    s_cbranch_vccz H_lwd_34
    s_sleep 16
    s_add_u32 s46, s46, 1
    s_cmp_lt_u32 s46, 160000
    s_cbranch_scc1 H_lw_33
H_lwd_34:
    ds_read2_b32 v[8:9], v10 offset0:0 offset1:32
    ds_read2_b32 v[10:11], v10 offset0:64 offset1:96
    ds_read2st64_b32 v[12:13], v26 offset0:0 offset1:1
    ds_read2st64_b32 v[14:15], v26 offset0:2 offset1:3
    ds_read2st64_b32 v[16:17], v26 offset0:8 offset1:9
    ds_read2st64_b32 v[18:19], v26 offset0:10 offset1:11
    ds_read2st64_b32 v[20:21], v26 offset0:16 offset1:17
    ds_read2st64_b32 v[22:23], v26 offset0:18 offset1:19
    ds_read2st64_b32 v[24:25], v26 offset0:24 offset1:25
    ds_read2st64_b32 v[26:27], v26 offset0:26 offset1:27
    s_waitcnt lgkmcnt(8)
    v_pk_add_f32 v[8:9], v[8:9], v[10:11]
    v_add_f32 v8, v8, v9
    v_add_f32 v8, v8, v1
    v_rcp_f32 v9, v8
    s_waitcnt lgkmcnt(4)
    v_pk_add_f32 v[12:13], v[12:13], v[16:17]
    v_pk_add_f32 v[14:15], v[14:15], v[18:19]
    v_pk_add_f32 v[12:13], v[12:13], v[28:29]
    v_pk_add_f32 v[14:15], v[14:15], v[30:31]
    v_lshrrev_b32 v11, 5, v0
    s_and_b32 s41, s51, 1
    s_lshl_b32 s41, s41, 4
    v_lshl_add_u32 v11, v11, 3, v3
    s_waitcnt lgkmcnt(0)
    v_pk_add_f32 v[20:21], v[20:21], v[24:25]
    v_pk_add_f32 v[22:23], v[22:23], v[26:27]
    v_add_u32 v11, s41, v11
    v_pk_add_f32 v[12:13], v[12:13], v[20:21]
    v_pk_add_f32 v[14:15], v[14:15], v[22:23]
    v_pk_mul_f32 v[12:13], v[12:13], v[8:9] op_sel:[0,1] op_sel_hi:[1,1]
    v_pk_mul_f32 v[14:15], v[14:15], v[8:9] op_sel:[0,1] op_sel_hi:[1,1]
    v_cvt_pk_bf16_f32 v16, v12, v13
    v_cvt_pk_bf16_f32 v17, v14, v15
    ds_write_b64 v11, v[16:17] offset:0
    v_pk_add_f32 v[12:13], v[12:13], v[14:15]
    v_add_f32 v12, v12, v13
    v_fma_f32 v8, v12, 0, v8
    v_subrev_u32 v8, 394264576, v8
    v_cmp_lt_u32 vcc, 1509949440, v8
    s_cbranch_vccz H_nb_35
    s_cmp_lg_u32 s19, 0
    s_cbranch_scc1 H_nb_35
    v_mov_b32 v8, 160768
    v_mov_b32 v9, 1
    ds_write_b32 v8, v9 offset:96
H_nb_35:
    s_andn2_b32 s41, s36, s19
    s_cbranch_scc0 H_c0_36
    v_lshrrev_b32 v28, 5, v0
    s_lshl_b32 s41, s51, 5
    s_add_u32 s41, s41, 142336
    v_lshl_add_u32 v28, v28, 4, s41
    ds_read_b128 v[8:11], v3 offset:18560
    ds_read_b128 v[12:15], v3 offset:18576
    ds_read_b128 v[28:31], v28
    s_waitcnt lgkmcnt(1)
    v_dot2_f32_bf16 v1, v8, s0, 0
    s_nop 2
    v_dot2_f32_bf16 v1, v9, s1, v1
    v_dot2_f32_bf16 v1, v10, s2, v1
    v_dot2_f32_bf16 v1, v11, s3, v1
    v_dot2_f32_bf16 v1, v12, s4, v1
    v_dot2_f32_bf16 v1, v13, s5, v1
    v_dot2_f32_bf16 v1, v14, s6, v1
    v_dot2_f32_bf16 v1, v15, s7, v1
    s_nop 2
    v_exp_f32 v1, v1
    s_waitcnt lgkmcnt(0)
    v_and_b32 v1, 0xffff0000, v1
    v_pk_mul_f32 v[28:29], v[28:29], v[0:1] op_sel:[0,1] op_sel_hi:[1,1]
    v_pk_mul_f32 v[30:31], v[30:31], v[0:1] op_sel:[0,1] op_sel_hi:[1,1]
    s_branch H_c1_37
H_c0_36:
    v_mov_b32 v1, 0
    v_mov_b64 v[28:29], 0
    v_mov_b64 v[30:31], 0
H_c1_37:
    v_and_b32 v10, 31, v0
    s_add_u32 s41, s45, 1024
    v_lshl_add_u32 v10, v10, 2, s41
    v_lshl_add_u32 v26, v0, 2, s44
    v_lshl_add_u32 v13, v0, 3, s45
    s_mov_b32 s46, 0
H_lw_38:
    ds_read_b32 v8, v13 offset:1024
    s_waitcnt lgkmcnt(0)
    v_cmp_eq_u32 vcc, -1, v8
    s_cbranch_vccz H_lwd_39
    s_sleep 8
    s_add_u32 s46, s46, 1
    s_cmp_lt_u32 s46, 160000
    s_cbranch_scc1 H_lw_38
H_lwd_39:
    ds_read2_b32 v[8:9], v10 offset0:0 offset1:32
    ds_read2_b32 v[10:11], v10 offset0:64 offset1:96
    ds_read2st64_b32 v[12:13], v26 offset0:64 offset1:65
    ds_read2st64_b32 v[14:15], v26 offset0:66 offset1:67
    ds_read2st64_b32 v[16:17], v26 offset0:72 offset1:73
    ds_read2st64_b32 v[18:19], v26 offset0:74 offset1:75
    ds_read2st64_b32 v[20:21], v26 offset0:80 offset1:81
    ds_read2st64_b32 v[22:23], v26 offset0:82 offset1:83
    ds_read2st64_b32 v[24:25], v26 offset0:88 offset1:89
    ds_read2st64_b32 v[26:27], v26 offset0:90 offset1:91
    s_waitcnt lgkmcnt(8)
    v_pk_add_f32 v[8:9], v[8:9], v[10:11]
    v_add_f32 v8, v8, v9
    v_add_f32 v8, v8, v1
    v_rcp_f32 v9, v8
    s_waitcnt lgkmcnt(4)
    v_pk_add_f32 v[12:13], v[12:13], v[16:17]
    v_pk_add_f32 v[14:15], v[14:15], v[18:19]
    v_pk_add_f32 v[12:13], v[12:13], v[28:29]
    v_pk_add_f32 v[14:15], v[14:15], v[30:31]
    v_lshrrev_b32 v11, 5, v0
    s_and_b32 s41, s51, 1
    s_lshl_b32 s41, s41, 4
    v_lshl_add_u32 v11, v11, 3, v3
    s_waitcnt lgkmcnt(0)
    v_pk_add_f32 v[20:21], v[20:21], v[24:25]
    v_pk_add_f32 v[22:23], v[22:23], v[26:27]
    v_add_u32 v11, s41, v11
    v_pk_add_f32 v[12:13], v[12:13], v[20:21]
    v_pk_add_f32 v[14:15], v[14:15], v[22:23]
    v_pk_mul_f32 v[12:13], v[12:13], v[8:9] op_sel:[0,1] op_sel_hi:[1,1]
    v_pk_mul_f32 v[14:15], v[14:15], v[8:9] op_sel:[0,1] op_sel_hi:[1,1]
    v_cvt_pk_bf16_f32 v16, v12, v13
    v_cvt_pk_bf16_f32 v17, v14, v15
    ds_write_b64 v11, v[16:17] offset:2176
    v_pk_add_f32 v[12:13], v[12:13], v[14:15]
    v_add_f32 v12, v12, v13
    v_fma_f32 v8, v12, 0, v8
    v_subrev_u32 v8, 394264576, v8
    v_cmp_lt_u32 vcc, 1509949440, v8
    s_cbranch_vccz H_nb_40
    s_cmp_lg_u32 s19, 0
    s_cbranch_scc1 H_nb_40
    v_mov_b32 v8, 160768
    v_mov_b32 v9, 1
    ds_write_b32 v8, v9 offset:96
H_nb_40:
    s_lshl_b32 s41, s36, 4
    s_add_u32 s41, s41, 160768
    v_mov_b32 v8, s41
    v_mov_b32 v11, 160768
    v_mov_b32 v9, 1
    s_mov_b64 exec, 1
    ds_add_u32 v8, v9 offset:64
    s_mov_b64 exec, -1
    s_mov_b32 s46, 0
W_42:
    ds_read_b32 v9, v8 offset:64
    s_waitcnt lgkmcnt(0)
    v_cmp_gt_u32 vcc, 4, v9
    s_cbranch_vccz Wd_43
    s_sleep 3
    s_add_u32 s46, s46, 1
    s_cmp_lt_u32 s46, 320000
    s_cbranch_scc1 W_42
Wd_43:
    ds_read_b32 v9, v11 offset:96
    s_waitcnt lgkmcnt(0)
    v_cmp_ne_u32 vcc, 0, v9
    s_cbranch_vccnz H_toX
    ds_read_b128 v[8:11], v2 offset:0
    ds_read_b128 v[12:15], v2 offset:64
    ds_read_b128 v[16:19], v2 offset:128
    ds_read_b128 v[20:23], v2 offset:192
    s_add_u32 s41, s37, 1
    s_and_b32 s41, s41, 3
    s_andn2_b32 s43, s18, 3
    s_add_u32 s41, s41, s43
    s_mul_i32 s41, s41, 49152
    s_add_u32 s41, s41, s50
    s_add_u32 s41, s41, 4096
    s_add_u32 s42, s37, 2
    s_and_b32 s42, s42, 3
    s_andn2_b32 s43, s18, 3
    s_add_u32 s42, s42, s43
    s_mul_i32 s42, s42, 49152
    s_add_u32 s42, s42, s50
    s_add_u32 s42, s42, 4096
    v_lshl_add_u32 v24, v0, 4, s42
    s_mov_b64 exec, s[98:99]
    v_lshl_add_u32 v24, v0, 4, s41
    s_mov_b64 exec, -1
    s_waitcnt vmcnt(0)
    s_setprio 0
    s_waitcnt lgkmcnt(0)
    v_mfma_f32_16x16x32_bf16 v[32:35], v[128:131], v[8:11], 0
    v_mfma_f32_16x16x32_bf16 v[32:35], v[160:163], v[12:15], v[32:35]
    v_mfma_f32_16x16x32_bf16 v[32:35], v[192:195], v[16:19], v[32:35]
    v_mfma_f32_16x16x32_bf16 v[32:35], v[224:227], v[20:23], v[32:35]
    v_mfma_f32_16x16x32_bf16 v[36:39], v[132:135], v[8:11], 0
    v_mfma_f32_16x16x32_bf16 v[36:39], v[164:167], v[12:15], v[36:39]
    v_mfma_f32_16x16x32_bf16 v[36:39], v[196:199], v[16:19], v[36:39]
    v_mfma_f32_16x16x32_bf16 v[36:39], v[228:231], v[20:23], v[36:39]
    v_mfma_f32_16x16x32_bf16 v[40:43], v[136:139], v[8:11], 0
    v_mfma_f32_16x16x32_bf16 v[40:43], v[168:171], v[12:15], v[40:43]
    v_mfma_f32_16x16x32_bf16 v[40:43], v[200:203], v[16:19], v[40:43]
    v_mfma_f32_16x16x32_bf16 v[40:43], v[232:235], v[20:23], v[40:43]
    global_store_dwordx4 v24, v[32:35], s[32:33] offset:-4096 sc1
    v_mfma_f32_16x16x32_bf16 v[44:47], v[140:143], v[8:11], 0
    v_mfma_f32_16x16x32_bf16 v[44:47], v[172:175], v[12:15], v[44:47]
    v_mfma_f32_16x16x32_bf16 v[44:47], v[204:207], v[16:19], v[44:47]
    v_mfma_f32_16x16x32_bf16 v[44:47], v[236:239], v[20:23], v[44:47]
    global_store_dwordx4 v24, v[36:39], s[32:33] offset:-3072 sc1
    v_mfma_f32_16x16x32_bf16 v[48:51], v[144:147], v[8:11], 0
    v_mfma_f32_16x16x32_bf16 v[48:51], v[176:179], v[12:15], v[48:51]
    v_mfma_f32_16x16x32_bf16 v[48:51], v[208:211], v[16:19], v[48:51]
    v_mfma_f32_16x16x32_bf16 v[48:51], v[240:243], v[20:23], v[48:51]
    global_store_dwordx4 v24, v[40:43], s[32:33] offset:-2048 sc1
    v_mfma_f32_16x16x32_bf16 v[52:55], v[148:151], v[8:11], 0
    v_mfma_f32_16x16x32_bf16 v[52:55], v[180:183], v[12:15], v[52:55]
    v_mfma_f32_16x16x32_bf16 v[52:55], v[212:215], v[16:19], v[52:55]
    v_mfma_f32_16x16x32_bf16 v[52:55], v[244:247], v[20:23], v[52:55]
    global_store_dwordx4 v24, v[44:47], s[32:33] offset:-1024 sc1
    v_mfma_f32_16x16x32_bf16 v[56:59], v[152:155], v[8:11], 0
    v_mfma_f32_16x16x32_bf16 v[56:59], v[184:187], v[12:15], v[56:59]
    v_mfma_f32_16x16x32_bf16 v[56:59], v[216:219], v[16:19], v[56:59]
    v_mfma_f32_16x16x32_bf16 v[56:59], v[248:251], v[20:23], v[56:59]
    global_store_dwordx4 v24, v[48:51], s[32:33] offset:0 sc1
    v_mfma_f32_16x16x32_bf16 v[60:63], v[156:159], v[8:11], 0
    v_mfma_f32_16x16x32_bf16 v[60:63], v[188:191], v[12:15], v[60:63]
    v_mfma_f32_16x16x32_bf16 v[60:63], v[220:223], v[16:19], v[60:63]
    v_mfma_f32_16x16x32_bf16 v[60:63], v[252:255], v[20:23], v[60:63]
    global_store_dwordx4 v24, v[52:55], s[32:33] offset:1024 sc1
    s_nop 1
    global_store_dwordx4 v24, v[56:59], s[32:33] offset:2048 sc1
    s_nop 3
    global_store_dwordx4 v24, v[60:63], s[32:33] offset:3072 sc1
    s_setprio 2
    v_lshlrev_b32 v13, 4, v0
    v_add_u32 v13, 158208, v13
    ds_read_b32 v8, v13
    s_mov_b32 s55, 2
    s_waitcnt lgkmcnt(0)
    v_cmp_eq_u32 vcc, -1, v8
    s_cbranch_vccz H_b1
    s_add_u32 s41, s37, 1
    v_add_u32 v25, s41, v0
    v_and_b32 v25, 3, v25
    v_lshlrev_b32 v25, 11, v25
    v_lshl_add_u32 v25, v0, 9, v25
    s_andn2_b32 s43, s18, 3
    s_lshl_b32 s41, s43, 11
    s_lshl_b32 s42, s51, 7
    s_add_u32 s41, s41, s42
    s_add_u32 s41, s41, 1572864
    v_add_u32 v25, s41, v25
    v_mov_b32 v27, s53
    s_waitcnt vmcnt(0)
    s_mov_b64 exec, 7
    global_store_dword v25, v27, s[32:33] sc1
    s_mov_b64 exec, -1
    s_mov_b32 s55, 0
    s_mul_i32 s41, s18, 49152
    s_add_u32 s41, s41, s50
    v_lshl_add_u32 v24, v0, 4, s41
    v_add_u32 v26, 4096, v24
    s_lshl_b32 s41, s18, 11
    s_lshl_b32 s42, s51, 7
    s_add_u32 s41, s41, s42
    s_add_u32 s41, s41, 1572864
    v_min_u32 v25, 2, v0
    v_lshl_add_u32 v25, v25, 9, s41
    s_mov_b32 s46, 0
H_nbp:
    ds_read_b32 v8, v13
    s_waitcnt lgkmcnt(0)
    v_cmp_eq_u32 vcc, -1, v8
    s_cbranch_vccz H_b1
    s_add_u32 s46, s46, 1
    s_cmp_ge_u32 s46, 40000
    s_cbranch_scc1 H_b1
    s_sleep 4
    global_load_dword v8, v25, s[32:33] sc1
    s_waitcnt vmcnt(0)
    v_cmp_ne_u32 vcc, s53, v8
    s_cbranch_vccnz H_nbp
    s_lshl_b32 s41, s51, 13
    s_add_u32 s41, s41, 65536
    s_add_u32 m0, s41, 0
    s_nop 0
    global_load_lds_dwordx4 v24, s[32:33] offset:0 sc1
    global_load_lds_dwordx4 v24, s[32:33] offset:1024 sc1
    global_load_lds_dwordx4 v24, s[32:33] offset:2048 sc1
    global_load_lds_dwordx4 v24, s[32:33] offset:3072 sc1
    s_add_u32 m0, s41, 4096
    s_nop 0
    global_load_lds_dwordx4 v26, s[32:33] offset:0 sc1
    global_load_lds_dwordx4 v26, s[32:33] offset:1024 sc1
    global_load_lds_dwordx4 v26, s[32:33] offset:2048 sc1
    global_load_lds_dwordx4 v26, s[32:33] offset:3072 sc1
    s_mov_b32 s55, 1
H_b1:
    s_andn2_b32 s41, s36, s19
    s_cbranch_scc0 H_c0_44
    v_lshrrev_b32 v28, 5, v0
    s_lshl_b32 s41, s51, 5
    s_add_u32 s41, s41, 142336
    v_lshl_add_u32 v28, v28, 4, s41
    ds_read_b128 v[8:11], v3 offset:20736
    ds_read_b128 v[12:15], v3 offset:20752
    ds_read_b128 v[28:31], v28
    s_waitcnt lgkmcnt(1)
    v_dot2_f32_bf16 v1, v8, s0, 0
    s_nop 2
    v_dot2_f32_bf16 v1, v9, s1, v1
    v_dot2_f32_bf16 v1, v10, s2, v1
    v_dot2_f32_bf16 v1, v11, s3, v1
    v_dot2_f32_bf16 v1, v12, s4, v1
    v_dot2_f32_bf16 v1, v13, s5, v1
    v_dot2_f32_bf16 v1, v14, s6, v1
    v_dot2_f32_bf16 v1, v15, s7, v1
    s_nop 2
    v_exp_f32 v1, v1
    s_waitcnt lgkmcnt(0)
    v_and_b32 v1, 0xffff0000, v1
    v_pk_mul_f32 v[28:29], v[28:29], v[0:1] op_sel:[0,1] op_sel_hi:[1,1]
    v_pk_mul_f32 v[30:31], v[30:31], v[0:1] op_sel:[0,1] op_sel_hi:[1,1]
    s_branch H_c1_45
H_c0_44:
    v_mov_b32 v1, 0
    v_mov_b64 v[28:29], 0
    v_mov_b64 v[30:31], 0
H_c1_45:
    v_and_b32 v10, 31, v0
    s_add_u32 s41, s45, 2048
    v_lshl_add_u32 v10, v10, 2, s41
    v_lshl_add_u32 v26, v0, 2, s44
    v_lshl_add_u32 v13, v0, 3, s45
    s_mov_b32 s46, 0
H_lw_46:
    ds_read_b32 v8, v13 offset:2048
    s_waitcnt lgkmcnt(0)
    v_cmp_eq_u32 vcc, -1, v8
    s_cbranch_vccz H_lwd_47
    s_sleep 4
    s_add_u32 s46, s46, 1
    s_cmp_lt_u32 s46, 160000
    s_cbranch_scc1 H_lw_46
H_lwd_47:
    ds_read2_b32 v[8:9], v10 offset0:0 offset1:32
    ds_read2_b32 v[10:11], v10 offset0:64 offset1:96
    ds_read2st64_b32 v[12:13], v26 offset0:128 offset1:129
    ds_read2st64_b32 v[14:15], v26 offset0:130 offset1:131
    ds_read2st64_b32 v[16:17], v26 offset0:136 offset1:137
    ds_read2st64_b32 v[18:19], v26 offset0:138 offset1:139
    ds_read2st64_b32 v[20:21], v26 offset0:144 offset1:145
    ds_read2st64_b32 v[22:23], v26 offset0:146 offset1:147
    ds_read2st64_b32 v[24:25], v26 offset0:152 offset1:153
    ds_read2st64_b32 v[26:27], v26 offset0:154 offset1:155
    s_waitcnt lgkmcnt(8)
    v_pk_add_f32 v[8:9], v[8:9], v[10:11]
    v_add_f32 v8, v8, v9
    v_add_f32 v8, v8, v1
    v_rcp_f32 v9, v8
    s_waitcnt lgkmcnt(4)
    v_pk_add_f32 v[12:13], v[12:13], v[16:17]
    v_pk_add_f32 v[14:15], v[14:15], v[18:19]
    v_pk_add_f32 v[12:13], v[12:13], v[28:29]
    v_pk_add_f32 v[14:15], v[14:15], v[30:31]
    v_lshrrev_b32 v11, 5, v0
    s_and_b32 s41, s51, 1
    s_lshl_b32 s41, s41, 4
    v_lshl_add_u32 v11, v11, 3, v3
    s_waitcnt lgkmcnt(0)
    v_pk_add_f32 v[20:21], v[20:21], v[24:25]
    v_pk_add_f32 v[22:23], v[22:23], v[26:27]
    v_add_u32 v11, s41, v11
    v_pk_add_f32 v[12:13], v[12:13], v[20:21]
    v_pk_add_f32 v[14:15], v[14:15], v[22:23]
    v_pk_mul_f32 v[12:13], v[12:13], v[8:9] op_sel:[0,1] op_sel_hi:[1,1]
    v_pk_mul_f32 v[14:15], v[14:15], v[8:9] op_sel:[0,1] op_sel_hi:[1,1]
    v_cvt_pk_bf16_f32 v16, v12, v13
    v_cvt_pk_bf16_f32 v17, v14, v15
    ds_write_b64 v11, v[16:17] offset:4352
    v_pk_add_f32 v[12:13], v[12:13], v[14:15]
    v_add_f32 v12, v12, v13
    v_fma_f32 v8, v12, 0, v8
    v_subrev_u32 v8, 394264576, v8
    v_cmp_lt_u32 vcc, 1509949440, v8
    s_cbranch_vccz H_nb_48
    s_cmp_lg_u32 s19, 0
    s_cbranch_scc1 H_nb_48
    v_mov_b32 v8, 160768
    v_mov_b32 v9, 1
    ds_write_b32 v8, v9 offset:96
H_nb_48:
    s_lshl_b32 s41, s36, 4
    s_add_u32 s41, s41, 160768
    v_mov_b32 v8, s41
    v_mov_b32 v11, 160768
    v_mov_b32 v9, 1
    s_mov_b64 exec, 1
    ds_add_u32 v8, v9 offset:68
    s_mov_b64 exec, -1
    s_mov_b32 s46, 0
W_50:
    ds_read_b32 v9, v8 offset:68
    s_waitcnt lgkmcnt(0)
    v_cmp_gt_u32 vcc, 4, v9
    s_cbranch_vccz Wd_51
    s_sleep 3
    s_add_u32 s46, s46, 1
    s_cmp_lt_u32 s46, 320000
    s_cbranch_scc1 W_50
Wd_51:
    ds_read_b32 v9, v11 offset:96
    s_waitcnt lgkmcnt(0)
    v_cmp_ne_u32 vcc, 0, v9
    s_cbranch_vccnz H_toX
    ds_read_b128 v[8:11], v2 offset:4352
    ds_read_b128 v[12:15], v2 offset:4416
    ds_read_b128 v[16:19], v2 offset:4480
    ds_read_b128 v[20:23], v2 offset:4544
    s_add_u32 s41, s37, 3
    s_and_b32 s41, s41, 3
    s_andn2_b32 s43, s18, 3
    s_add_u32 s41, s41, s43
    s_mul_i32 s41, s41, 49152
    s_add_u32 s41, s41, s50
    s_add_u32 s41, s41, 8192
    v_lshl_add_u32 v24, v0, 4, s41
    s_setprio 0
    s_waitcnt lgkmcnt(0)
    v_mfma_f32_16x16x32_bf16 v[32:35], v[128:131], v[8:11], 0
    v_mfma_f32_16x16x32_bf16 v[32:35], v[160:163], v[12:15], v[32:35]
    v_mfma_f32_16x16x32_bf16 v[32:35], v[192:195], v[16:19], v[32:35]
    v_mfma_f32_16x16x32_bf16 v[32:35], v[224:227], v[20:23], v[32:35]
    v_mfma_f32_16x16x32_bf16 v[36:39], v[132:135], v[8:11], 0
    v_mfma_f32_16x16x32_bf16 v[36:39], v[164:167], v[12:15], v[36:39]
    v_mfma_f32_16x16x32_bf16 v[36:39], v[196:199], v[16:19], v[36:39]
    v_mfma_f32_16x16x32_bf16 v[36:39], v[228:231], v[20:23], v[36:39]
    v_mfma_f32_16x16x32_bf16 v[40:43], v[136:139], v[8:11], 0
    v_mfma_f32_16x16x32_bf16 v[40:43], v[168:171], v[12:15], v[40:43]
    v_mfma_f32_16x16x32_bf16 v[40:43], v[200:203], v[16:19], v[40:43]
    v_mfma_f32_16x16x32_bf16 v[40:43], v[232:235], v[20:23], v[40:43]
    s_mov_b64 exec, s[98:99]
    global_store_dwordx4 v24, v[32:35], s[32:33] offset:0 sc1
    s_mov_b64 exec, -1
    v_mfma_f32_16x16x32_bf16 v[44:47], v[140:143], v[8:11], 0
    v_mfma_f32_16x16x32_bf16 v[44:47], v[172:175], v[12:15], v[44:47]
    v_mfma_f32_16x16x32_bf16 v[44:47], v[204:207], v[16:19], v[44:47]
    v_mfma_f32_16x16x32_bf16 v[44:47], v[236:239], v[20:23], v[44:47]
    s_mov_b64 exec, s[98:99]
    global_store_dwordx4 v24, v[36:39], s[32:33] offset:1024 sc1
    s_mov_b64 exec, -1
    v_mfma_f32_16x16x32_bf16 v[48:51], v[144:147], v[8:11], 0
    v_mfma_f32_16x16x32_bf16 v[48:51], v[176:179], v[12:15], v[48:51]
    v_mfma_f32_16x16x32_bf16 v[48:51], v[208:211], v[16:19], v[48:51]
    v_mfma_f32_16x16x32_bf16 v[48:51], v[240:243], v[20:23], v[48:51]
    s_mov_b64 exec, s[98:99]
    global_store_dwordx4 v24, v[40:43], s[32:33] offset:2048 sc1
    s_mov_b64 exec, -1
    v_mfma_f32_16x16x32_bf16 v[52:55], v[148:151], v[8:11], 0
    v_mfma_f32_16x16x32_bf16 v[52:55], v[180:183], v[12:15], v[52:55]
    v_mfma_f32_16x16x32_bf16 v[52:55], v[212:215], v[16:19], v[52:55]
    v_mfma_f32_16x16x32_bf16 v[52:55], v[244:247], v[20:23], v[52:55]
    s_mov_b64 exec, s[98:99]
    global_store_dwordx4 v24, v[44:47], s[32:33] offset:3072 sc1
    s_mov_b64 exec, -1
    v_mfma_f32_16x16x32_bf16 v[56:59], v[152:155], v[8:11], 0
    v_mfma_f32_16x16x32_bf16 v[56:59], v[184:187], v[12:15], v[56:59]
    v_mfma_f32_16x16x32_bf16 v[56:59], v[216:219], v[16:19], v[56:59]
    v_mfma_f32_16x16x32_bf16 v[56:59], v[248:251], v[20:23], v[56:59]
    s_mov_b64 exec, s[98:99]
    global_store_dwordx4 v24, v[48:51], s[32:33] offset:128 sc1
    s_mov_b64 exec, -1
    v_mfma_f32_16x16x32_bf16 v[60:63], v[156:159], v[8:11], 0
    v_mfma_f32_16x16x32_bf16 v[60:63], v[188:191], v[12:15], v[60:63]
    v_mfma_f32_16x16x32_bf16 v[60:63], v[220:223], v[16:19], v[60:63]
    v_mfma_f32_16x16x32_bf16 v[60:63], v[252:255], v[20:23], v[60:63]
    s_mov_b64 exec, s[98:99]
    global_store_dwordx4 v24, v[52:55], s[32:33] offset:1152 sc1
    s_mov_b64 exec, -1
    s_mov_b64 exec, s[98:99]
    global_store_dwordx4 v24, v[56:59], s[32:33] offset:2176 sc1
    s_mov_b64 exec, -1
    s_mov_b64 exec, s[98:99]
    s_nop 0
    global_store_dwordx4 v24, v[60:63], s[32:33] offset:3200 sc1
    s_mov_b64 exec, -1
    s_setprio 2
    s_cmp_eq_u32 s55, 1
    s_cbranch_scc1 H_r2
    s_cmp_eq_u32 s55, 0
    s_cbranch_scc1 H_r1
    s_mov_b32 s55, 0
    s_add_u32 s41, s37, 1
    v_add_u32 v25, s41, v0
    v_and_b32 v25, 3, v25
    v_lshlrev_b32 v25, 11, v25
    v_lshl_add_u32 v25, v0, 9, v25
    s_andn2_b32 s43, s18, 3
    s_lshl_b32 s41, s43, 11
    s_lshl_b32 s42, s51, 7
    s_add_u32 s41, s41, s42
    s_add_u32 s41, s41, 1572864
    v_add_u32 v25, s41, v25
    v_mov_b32 v27, s53
    s_waitcnt vmcnt(0)
    s_mov_b64 exec, 7
    global_store_dword v25, v27, s[32:33] sc1
    s_mov_b64 exec, -1
H_r1:
    s_mul_i32 s41, s18, 49152
    s_add_u32 s41, s41, s50
    v_lshl_add_u32 v24, v0, 4, s41
    v_add_u32 v26, 4096, v24
    s_lshl_b32 s41, s18, 11
    s_lshl_b32 s42, s51, 7
    s_add_u32 s41, s41, s42
    s_add_u32 s41, s41, 1572864
    v_min_u32 v25, 2, v0
    v_lshl_add_u32 v25, v25, 9, s41
    s_mov_b32 s46, 0
H_fp_52:
    global_load_dword v8, v25, s[32:33] sc1
    s_waitcnt vmcnt(0)
    v_cmp_ne_u32 vcc, s53, v8
    s_cbranch_vccz H_fpd_53
    s_sleep 2
    s_add_u32 s46, s46, 1
    s_cmp_lt_u32 s46, 40000
    s_cbranch_scc1 H_fp_52
H_fpd_53:
    global_load_dwordx4 v[32:35], v26, s[32:33] offset:-4096 sc1
    global_load_dwordx4 v[36:39], v26, s[32:33] offset:-3072 sc1
    global_load_dwordx4 v[40:43], v26, s[32:33] offset:-2048 sc1
    global_load_dwordx4 v[44:47], v26, s[32:33] offset:-1024 sc1
    global_load_dwordx4 v[48:51], v26, s[32:33] offset:0 sc1
    global_load_dwordx4 v[52:55], v26, s[32:33] offset:1024 sc1
    global_load_dwordx4 v[56:59], v26, s[32:33] offset:2048 sc1
    global_load_dwordx4 v[60:63], v26, s[32:33] offset:3072 sc1
H_r2:
    s_mul_i32 s41, s18, 49152
    s_add_u32 s41, s41, s50
    s_add_u32 s41, s41, 8192
    v_lshl_add_u32 v26, v0, 4, s41
    s_cmp_lg_u32 s36, 0
    s_cbranch_scc1 H_npf
    s_lshl_b32 s41, s51, 12
    v_lshl_add_u32 v8, v0, 6, s41
    global_load_dword v28, v8, s[12:13]
    global_load_dword v29, v8, s[14:15]
H_npf:
    s_mov_b32 s46, 0
    s_cmp_eq_u32 s55, 0
    s_cbranch_scc1 H_p2
    s_sleep 24
H_p2:
    global_load_dwordx4 v[8:11], v26, s[32:33] offset:0 sc1
    global_load_dwordx4 v[12:15], v26, s[32:33] offset:1024 sc1
    global_load_dwordx4 v[16:19], v26, s[32:33] offset:2048 sc1
    global_load_dwordx4 v[20:23], v26, s[32:33] offset:3072 sc1
    s_waitcnt vmcnt(0)
    v_max3_u32 v24, v8, v12, v16
    v_max_u32 v24, v24, v20
    v_cmp_eq_u32 vcc, -1, v24
    s_cbranch_vccz H_p2d_54
    s_sleep 4
    s_add_u32 s46, s46, 1
    s_cmp_lt_u32 s46, 40000
    s_cbranch_scc1 H_p2
H_p2d_54:
    s_cmp_eq_u32 s55, 0
    s_cbranch_scc1 H_r3
    s_lshl_b32 s41, s51, 13
    s_add_u32 s41, s41, 65536
    v_lshl_add_u32 v24, v0, 4, s41
    ds_read_b128 v[32:35], v24 offset:0
    ds_read_b128 v[36:39], v24 offset:1024
    ds_read_b128 v[40:43], v24 offset:2048
    ds_read_b128 v[44:47], v24 offset:3072
    ds_read_b128 v[48:51], v24 offset:4096
    ds_read_b128 v[52:55], v24 offset:5120
    ds_read_b128 v[56:59], v24 offset:6144
    ds_read_b128 v[60:63], v24 offset:7168
    s_waitcnt lgkmcnt(0)
H_r3:
    s_mov_b64 exec, s[98:99]
    v_pk_add_f32 v[32:33], v[32:33], v[8:9]
    v_pk_add_f32 v[34:35], v[34:35], v[10:11]
    v_pk_add_f32 v[36:37], v[36:37], v[12:13]
    v_pk_add_f32 v[38:39], v[38:39], v[14:15]
    v_pk_add_f32 v[40:41], v[40:41], v[16:17]
    v_pk_add_f32 v[42:43], v[42:43], v[18:19]
    v_pk_add_f32 v[44:45], v[44:45], v[20:21]
    v_pk_add_f32 v[46:47], v[46:47], v[22:23]
    s_not_b64 exec, s[98:99]
    v_pk_add_f32 v[48:49], v[48:49], v[8:9]
    v_pk_add_f32 v[50:51], v[50:51], v[10:11]
    v_pk_add_f32 v[52:53], v[52:53], v[12:13]
    v_pk_add_f32 v[54:55], v[54:55], v[14:15]
    v_pk_add_f32 v[56:57], v[56:57], v[16:17]
    v_pk_add_f32 v[58:59], v[58:59], v[18:19]
    v_pk_add_f32 v[60:61], v[60:61], v[20:21]
    v_pk_add_f32 v[62:63], v[62:63], v[22:23]
    s_mov_b64 exec, -1
    s_cmp_lg_u32 s36, 0
    s_cbranch_scc1 H_nwf
    s_add_u32 s6, s51, 0
    s_lshl_b32 s41, s37, 3
    s_add_u32 s41, s41, s6
    s_add_u32 s41, s41, 8
    s_and_b32 s41, s41, 31
    s_andn2_b32 s43, s49, 31
    s_add_u32 s41, s41, s43
    s_lshl_b32 s41, s41, 10
    s_add_u32 s3, s41, 2099200
    s_add_u32 s6, s51, 8
    s_lshl_b32 s41, s37, 3
    s_add_u32 s41, s41, s6
    s_add_u32 s41, s41, 8
    s_and_b32 s41, s41, 31
    s_andn2_b32 s43, s49, 31
    s_add_u32 s41, s41, s43
    s_lshl_b32 s41, s41, 10
    s_add_u32 s4, s41, 2099200
    s_add_u32 s6, s51, 16
    s_lshl_b32 s41, s37, 3
    s_add_u32 s41, s41, s6
    s_add_u32 s41, s41, 8
    s_and_b32 s41, s41, 31
    s_andn2_b32 s43, s49, 31
    s_add_u32 s41, s41, s43
    s_lshl_b32 s41, s41, 10
    s_add_u32 s5, s41, 2099200
H_nwf:
    v_and_b32 v8, 8, v0
    v_cmp_eq_u32 vcc, 0, v8
    v_lshrrev_b32 v8, 4, v0
    v_lshlrev_b32 v8, 4, v8
    v_add_u32 v8, 155008, v8
    v_cndmask_b32 v2, v8, v2, vcc
    s_andn2_b32 s41, s36, s19
    s_cbranch_scc0 H_c0_55
    v_lshrrev_b32 v28, 5, v0
    s_lshl_b32 s41, s51, 5
    s_add_u32 s41, s41, 142336
    v_lshl_add_u32 v28, v28, 4, s41
    ds_read_b128 v[8:11], v3 offset:22912
    ds_read_b128 v[12:15], v3 offset:22928
    ds_read_b128 v[28:31], v28
    s_waitcnt lgkmcnt(1)
    v_dot2_f32_bf16 v1, v8, s0, 0
    s_nop 2
    v_dot2_f32_bf16 v1, v9, s1, v1
    v_dot2_f32_bf16 v1, v10, s2, v1
    v_dot2_f32_bf16 v1, v11, s3, v1
    v_dot2_f32_bf16 v1, v12, s4, v1
    v_dot2_f32_bf16 v1, v13, s5, v1
    v_dot2_f32_bf16 v1, v14, s6, v1
    v_dot2_f32_bf16 v1, v15, s7, v1
    s_nop 2
    v_exp_f32 v1, v1
    s_waitcnt lgkmcnt(0)
    v_and_b32 v1, 0xffff0000, v1
    v_pk_mul_f32 v[28:29], v[28:29], v[0:1] op_sel:[0,1] op_sel_hi:[1,1]
    v_pk_mul_f32 v[30:31], v[30:31], v[0:1] op_sel:[0,1] op_sel_hi:[1,1]
    s_branch H_c1_56
H_c0_55:
    v_mov_b32 v1, 0
    v_mov_b64 v[28:29], 0
    v_mov_b64 v[30:31], 0
H_c1_56:
    v_and_b32 v10, 31, v0
    s_add_u32 s41, s45, 3072
    v_lshl_add_u32 v10, v10, 2, s41
    v_lshl_add_u32 v26, v0, 2, s44
    s_barrier
    ds_read2_b32 v[8:9], v10 offset0:0 offset1:32
    ds_read2_b32 v[10:11], v10 offset0:64 offset1:96
    ds_read2st64_b32 v[12:13], v26 offset0:192 offset1:193
    ds_read2st64_b32 v[14:15], v26 offset0:194 offset1:195
    ds_read2st64_b32 v[16:17], v26 offset0:200 offset1:201
    ds_read2st64_b32 v[18:19], v26 offset0:202 offset1:203
    ds_read2st64_b32 v[20:21], v26 offset0:208 offset1:209
    ds_read2st64_b32 v[22:23], v26 offset0:210 offset1:211
    ds_read2st64_b32 v[24:25], v26 offset0:216 offset1:217
    ds_read2st64_b32 v[26:27], v26 offset0:218 offset1:219
    s_waitcnt lgkmcnt(8)
    v_pk_add_f32 v[8:9], v[8:9], v[10:11]
    v_add_f32 v8, v8, v9
    v_add_f32 v8, v8, v1
    v_rcp_f32 v9, v8
    s_waitcnt lgkmcnt(4)
    v_pk_add_f32 v[12:13], v[12:13], v[16:17]
    v_pk_add_f32 v[14:15], v[14:15], v[18:19]
    v_pk_add_f32 v[12:13], v[12:13], v[28:29]
    v_pk_add_f32 v[14:15], v[14:15], v[30:31]
    v_lshrrev_b32 v11, 5, v0
    s_and_b32 s41, s51, 1
    s_lshl_b32 s41, s41, 4
    v_lshl_add_u32 v11, v11, 3, v3
    s_waitcnt lgkmcnt(0)
    v_pk_add_f32 v[20:21], v[20:21], v[24:25]
    v_pk_add_f32 v[22:23], v[22:23], v[26:27]
    v_add_u32 v11, s41, v11
    v_pk_add_f32 v[12:13], v[12:13], v[20:21]
    v_pk_add_f32 v[14:15], v[14:15], v[22:23]
    v_pk_mul_f32 v[12:13], v[12:13], v[8:9] op_sel:[0,1] op_sel_hi:[1,1]
    v_pk_mul_f32 v[14:15], v[14:15], v[8:9] op_sel:[0,1] op_sel_hi:[1,1]
    v_cvt_pk_bf16_f32 v16, v12, v13
    v_cvt_pk_bf16_f32 v17, v14, v15
    ds_write_b64 v11, v[16:17] offset:6528
    v_pk_add_f32 v[12:13], v[12:13], v[14:15]
    v_add_f32 v12, v12, v13
    v_fma_f32 v8, v12, 0, v8
    v_subrev_u32 v8, 394264576, v8
    v_cmp_lt_u32 vcc, 1509949440, v8
    s_cbranch_vccz H_nb_57
    s_cmp_lg_u32 s19, 0
    s_cbranch_scc1 H_nb_57
    v_mov_b32 v8, 160768
    v_mov_b32 v9, 1
    ds_write_b32 v8, v9 offset:96
H_nb_57:
    v_mov_b32 v24, 160768
    s_waitcnt lgkmcnt(0)
    s_barrier
    ds_read_b32 v24, v24 offset:96
    ds_read_b128 v[8:11], v2 offset:6528
    ds_read_b128 v[12:15], v2 offset:6592
    ds_read_b128 v[16:19], v2 offset:6656
    ds_read_b128 v[20:23], v2 offset:6720
    v_lshrrev_b32 v26, 4, v0
    v_and_b32 v25, 15, v0
    v_mul_u32_u24 v25, 2064, v25
    v_lshl_add_u32 v25, v26, 4, v25
    s_lshl_b32 s41, s51, 9
    s_add_u32 s41, s41, 65536
    v_add_u32 v1, s41, v25
    s_waitcnt lgkmcnt(4)
    v_cmp_ne_u32 vcc, 0, v24
    s_cbranch_vccnz H_slow
    s_waitcnt lgkmcnt(3)
    v_mfma_f32_16x16x32_bf16 v[32:35], v[128:131], v[8:11], v[32:35]
    v_mfma_f32_16x16x32_bf16 v[36:39], v[132:135], v[8:11], v[36:39]
    s_waitcnt lgkmcnt(2)
    v_mfma_f32_16x16x32_bf16 v[32:35], v[160:163], v[12:15], v[32:35]
    v_mfma_f32_16x16x32_bf16 v[36:39], v[164:167], v[12:15], v[36:39]
    s_waitcnt lgkmcnt(1)
    v_mfma_f32_16x16x32_bf16 v[32:35], v[192:195], v[16:19], v[32:35]
    v_mfma_f32_16x16x32_bf16 v[36:39], v[196:199], v[16:19], v[36:39]
    s_waitcnt lgkmcnt(0)
    v_mfma_f32_16x16x32_bf16 v[32:35], v[224:227], v[20:23], v[32:35]
    v_mfma_f32_16x16x32_bf16 v[36:39], v[228:231], v[20:23], v[36:39]
    v_mfma_f32_16x16x32_bf16 v[40:43], v[136:139], v[8:11], v[40:43]
    v_mfma_f32_16x16x32_bf16 v[40:43], v[168:171], v[12:15], v[40:43]
    v_mfma_f32_16x16x32_bf16 v[40:43], v[200:203], v[16:19], v[40:43]
    v_mfma_f32_16x16x32_bf16 v[40:43], v[232:235], v[20:23], v[40:43]
    v_mfma_f32_16x16x32_bf16 v[44:47], v[140:143], v[8:11], v[44:47]
    v_mfma_f32_16x16x32_bf16 v[44:47], v[172:175], v[12:15], v[44:47]
    v_mfma_f32_16x16x32_bf16 v[44:47], v[204:207], v[16:19], v[44:47]
    v_mfma_f32_16x16x32_bf16 v[44:47], v[236:239], v[20:23], v[44:47]
    ds_write_b128 v1, v[32:35] offset:0
    v_mfma_f32_16x16x32_bf16 v[48:51], v[144:147], v[8:11], v[48:51]
    v_mfma_f32_16x16x32_bf16 v[48:51], v[176:179], v[12:15], v[48:51]
    v_mfma_f32_16x16x32_bf16 v[48:51], v[208:211], v[16:19], v[48:51]
    v_mfma_f32_16x16x32_bf16 v[48:51], v[240:243], v[20:23], v[48:51]
    ds_write_b128 v1, v[36:39] offset:64
    v_mfma_f32_16x16x32_bf16 v[52:55], v[148:151], v[8:11], v[52:55]
    v_mfma_f32_16x16x32_bf16 v[52:55], v[180:183], v[12:15], v[52:55]
    v_mfma_f32_16x16x32_bf16 v[52:55], v[212:215], v[16:19], v[52:55]
    v_mfma_f32_16x16x32_bf16 v[52:55], v[244:247], v[20:23], v[52:55]
    ds_write_b128 v1, v[40:43] offset:128
    v_mfma_f32_16x16x32_bf16 v[56:59], v[152:155], v[8:11], v[56:59]
    v_mfma_f32_16x16x32_bf16 v[56:59], v[184:187], v[12:15], v[56:59]
    v_mfma_f32_16x16x32_bf16 v[56:59], v[216:219], v[16:19], v[56:59]
    v_mfma_f32_16x16x32_bf16 v[56:59], v[248:251], v[20:23], v[56:59]
    ds_write_b128 v1, v[44:47] offset:192
    v_mfma_f32_16x16x32_bf16 v[60:63], v[156:159], v[8:11], v[60:63]
    v_mfma_f32_16x16x32_bf16 v[60:63], v[188:191], v[12:15], v[60:63]
    v_mfma_f32_16x16x32_bf16 v[60:63], v[220:223], v[16:19], v[60:63]
    v_mfma_f32_16x16x32_bf16 v[60:63], v[252:255], v[20:23], v[60:63]
    ds_write_b128 v1, v[48:51] offset:256
    ds_write_b128 v1, v[52:55] offset:320
    s_nop 0
    ds_write_b128 v1, v[56:59] offset:384
    s_nop 3
    ds_write_b128 v1, v[60:63] offset:448
    s_setprio 0
    s_branch R_P4
H_FF2:
    v_mov_b64 v[40:41], v[64:65]
    v_mov_b64 v[42:43], v[66:67]
    v_mov_b64 v[44:45], v[68:69]
    v_mov_b64 v[46:47], v[70:71]
    v_mov_b64 v[48:49], v[72:73]
    v_mov_b64 v[50:51], v[74:75]
    v_mov_b64 v[52:53], v[76:77]
    v_mov_b64 v[54:55], v[78:79]
    v_mov_b64 v[56:57], v[80:81]
    v_mov_b64 v[58:59], v[82:83]
    v_mov_b64 v[60:61], v[84:85]
    v_mov_b64 v[62:63], v[86:87]
H_FFN:
    v_lshrrev_b32 v20, 4, v0
    s_lshl_b32 s41, s51, 6
    s_add_u32 s41, s41, 160896
    v_lshl_add_u32 v20, v20, 4, s41
    v_and_b32 v22, 1, v0
    v_bfe_u32 v21, v0, 1, 2
    v_lshlrev_b32 v21, 2, v21
    v_lshl_add_u32 v21, v22, 4, v21
    v_add_u32 v21, 160896, v21
    s_lshl_b32 s41, s47, 7
    s_lshl_b32 s42, s54, 15
    s_add_u32 s41, s41, s42
    s_add_u32 s41, s41, 4259840
    v_lshl_add_u32 v22, v0, 1, s41
    v_mov_b32 v23, 1
    v_lshrrev_b32 v24, 5, v0
    s_lshl_b32 s41, s51, 3
    s_add_u32 s41, s41, 161168
    v_lshl_add_u32 v24, v24, 2, s41
    s_lshl_b32 s41, s54, 4
    v_add_u32 v10, s41, v3
    s_mov_b32 s46, 0
K_g_58:
    ds_read_b128 v[16:19], v10 offset:480
    s_waitcnt lgkmcnt(0)
    v_min3_u32 v8, v16, v17, v18
    v_min_u32 v8, v8, v19
    v_cmp_eq_u32 vcc, 0, v8
    s_cbranch_vccz K_gd_59
    s_add_u32 s46, s46, 1
    s_cmp_lt_u32 s46, 320000
    s_cbranch_scc1 K_g_58
K_gd_59:
    v_max3_u32 v8, v16, v17, v18
    v_max_u32 v8, v8, v19
    s_nop 0
    v_readfirstlane_b32 s48, v8
    s_sub_u32 s48, s48, 1
    s_and_b32 s41, s48, 0x7ff
    s_sub_u32 s52, 2047, s41
    s_cmp_lg_u32 s54, 0
    s_cbranch_scc1 H_nl
    s_lshl_b32 s41, s47, 15
    s_lshl_b32 s42, s51, 13
    s_add_u32 s41, s41, s42
    s_add_u32 s41, s41, 33558528
    v_lshl_add_u32 v2, v0, 4, s41
    global_load_dwordx4 v[40:43], v2, s[32:33] offset:-4096 sc1
    global_load_dwordx4 v[44:47], v2, s[32:33] offset:-3072 sc1
    global_load_dwordx4 v[48:51], v2, s[32:33] offset:-2048 sc1
    global_load_dwordx4 v[52:55], v2, s[32:33] offset:-1024 sc1
    global_load_dwordx4 v[56:59], v2, s[32:33] offset:0 sc1
    global_load_dwordx4 v[60:63], v2, s[32:33] offset:1024 sc1
H_nl:
    s_lshr_b32 s41, s52, 3
    s_lshl_b32 s41, s41, 11
    s_lshl_b32 s42, s54, 19
    s_add_u32 s41, s41, s42
    s_add_u32 s41, s41, 524288
    s_lshl_b32 s42, s51, 8
    s_add_u32 s42, s42, s41
    v_lshl_add_u32 v2, v0, 2, s42
    s_lshl_b32 s42, s47, 2
    s_add_u32 s42, s42, s41
    v_mov_b32 v9, s42
    s_lshl_b32 s42, s54, 2
    v_add_u32 v37, s42, v3
    s_mov_b32 s46, 0
H_xs:
    global_load_dword v8, v2, s[32:33] sc1
    global_load_dword v38, v9, s[32:33] sc1
    global_load_dword v39, v9, s[32:33] offset:1024 sc1
    s_waitcnt vmcnt(0)
    v_max3_u32 v10, v8, v38, v39
    v_cmp_eq_u32 vcc, -1, v10
    s_cbranch_vccz H_xsd_60
    s_add_u32 s46, s46, 1
    s_cmp_lt_u32 s46, 40000
    s_cbranch_scc1 H_xs
H_xsd_60:
    s_cmp_ge_u32 s47, 224
    s_cbranch_scc1 H_down
    v_dot2_f32_bf16 v40, v40, v8, 0
    v_dot2_f32_bf16 v41, v41, v8, 0
    v_dot2_f32_bf16 v42, v42, v8, 0
    v_dot2_f32_bf16 v43, v43, v8, 0
    v_dot2_f32_bf16 v44, v44, v8, 0
    v_dot2_f32_bf16 v45, v45, v8, 0
    v_dot2_f32_bf16 v46, v46, v8, 0
    v_dot2_f32_bf16 v47, v47, v8, 0
    v_dot2_f32_bf16 v48, v48, v8, 0
    v_dot2_f32_bf16 v49, v49, v8, 0
    v_dot2_f32_bf16 v50, v50, v8, 0
    v_dot2_f32_bf16 v51, v51, v8, 0
    v_dot2_f32_bf16 v52, v52, v8, 0
    v_dot2_f32_bf16 v53, v53, v8, 0
    v_dot2_f32_bf16 v54, v54, v8, 0
    v_dot2_f32_bf16 v55, v55, v8, 0
    v_permlane32_swap_b32 v40, v48
    v_permlane32_swap_b32 v41, v49
    v_permlane32_swap_b32 v42, v50
    v_permlane32_swap_b32 v43, v51
    v_permlane32_swap_b32 v44, v52
    v_permlane32_swap_b32 v45, v53
    v_permlane32_swap_b32 v46, v54
    v_permlane32_swap_b32 v47, v55
    v_pk_add_f32 v[40:41], v[40:41], v[48:49]
    v_pk_add_f32 v[42:43], v[42:43], v[50:51]
    v_pk_add_f32 v[44:45], v[44:45], v[52:53]
    v_pk_add_f32 v[46:47], v[46:47], v[54:55]
    s_nop 0
    v_permlane16_swap_b32 v40, v44
    v_permlane16_swap_b32 v41, v45
    v_permlane16_swap_b32 v42, v46
    v_permlane16_swap_b32 v43, v47
    v_pk_add_f32 v[40:41], v[40:41], v[44:45]
    v_pk_add_f32 v[42:43], v[42:43], v[46:47]
    s_nop 0
    v_add_f32_dpp v40, v40, v40 row_ror:8 row_mask:0xf bank_mask:0xf
    v_add_f32_dpp v41, v41, v41 row_ror:8 row_mask:0xf bank_mask:0xf
    v_add_f32_dpp v42, v42, v42 row_ror:8 row_mask:0xf bank_mask:0xf
    v_add_f32_dpp v43, v43, v43 row_ror:8 row_mask:0xf bank_mask:0xf
    v_add_f32_dpp v40, v40, v40 row_ror:4 row_mask:0xf bank_mask:0xf
    v_add_f32_dpp v41, v41, v41 row_ror:4 row_mask:0xf bank_mask:0xf
    v_add_f32_dpp v42, v42, v42 row_ror:4 row_mask:0xf bank_mask:0xf
    v_add_f32_dpp v43, v43, v43 row_ror:4 row_mask:0xf bank_mask:0xf
    v_add_f32_dpp v40, v40, v40 row_ror:2 row_mask:0xf bank_mask:0xf
    v_add_f32_dpp v41, v41, v41 row_ror:2 row_mask:0xf bank_mask:0xf
    v_add_f32_dpp v42, v42, v42 row_ror:2 row_mask:0xf bank_mask:0xf
    v_add_f32_dpp v43, v43, v43 row_ror:2 row_mask:0xf bank_mask:0xf
    v_add_f32_dpp v40, v40, v40 row_ror:1 row_mask:0xf bank_mask:0xf
    v_add_f32_dpp v41, v41, v41 row_ror:1 row_mask:0xf bank_mask:0xf
    v_add_f32_dpp v42, v42, v42 row_ror:1 row_mask:0xf bank_mask:0xf
    v_add_f32_dpp v43, v43, v43 row_ror:1 row_mask:0xf bank_mask:0xf
    s_mov_b32 exec_lo, 0x00010001
    s_mov_b32 exec_hi, 0x00010001
    ds_write_b128 v20, v[40:43]
    s_mov_b64 exec, 1
    ds_add_rtn_u32 v10, v37, v23 offset:384
    s_mov_b64 exec, -1
    ds_read2_b32 v[12:13], v21 offset0:0 offset1:8
    ds_read2_b32 v[14:15], v21 offset0:16 offset1:24
    ds_read2_b32 v[16:17], v21 offset0:32 offset1:40
    ds_read2_b32 v[18:19], v21 offset0:48 offset1:56
    s_waitcnt lgkmcnt(0)
    v_readfirstlane_b32 s42, v10
    s_cmp_lg_u32 s42, 3
    s_cbranch_scc1 H_down
    v_pk_add_f32 v[12:13], v[12:13], v[14:15]
    v_pk_add_f32 v[16:17], v[16:17], v[18:19]
    v_pk_add_f32 v[12:13], v[12:13], v[16:17]
    v_cvt_pk_bf16_f32 v12, v12, v13
    v_and_b32 v13, 0xffff0000, v12
    v_lshlrev_b32 v12, 16, v12
    v_mul_f32 v14, 0xbfb8aa3b, v12
    v_exp_f32 v14, v14
    s_nop 0
    v_add_f32 v14, 1.0, v14
    v_rcp_f32 v14, v14
    s_nop 0
    v_mul_f32 v12, v12, v14
    v_cvt_pk_bf16_f32 v12, v12, v12
    v_lshlrev_b32 v12, 16, v12
    v_mul_f32 v12, v12, v13
    s_nop 1
    v_mov_b32_dpp v13, v12 quad_perm:[1,1,3,3] row_mask:0xf bank_mask:0xf
    v_cvt_pk_bf16_f32 v12, v12, v13
    s_mov_b64 exec, 0x55
    global_store_dword v22, v12, s[32:33] sc1
    s_mov_b64 exec, -1
H_down:
    s_lshl_b32 s41, s51, 6
    v_add_u32 v1, s41, v0
    v_min_u32 v2, 223, v1
    s_lshl_b32 s42, s54, 15
    s_add_u32 s42, s42, 4259840
    v_lshl_add_u32 v2, v2, 7, s42
    s_mov_b32 s46, 0
    s_cmp_lg_u32 s54, 0
    s_cbranch_scc1 H_nkw
    s_sleep 20
H_nkw:
    s_and_b32 s41, s54, s55
    s_cbranch_scc0 H_ncs
    s_cmp_eq_u32 s52, s49
    s_cbranch_scc1 H_ncs
    s_lshl_b32 s41, s49, 10
    v_lshl_add_u32 v9, v0, 4, s41
    global_store_dwordx4 v9, v[4:7], s[28:29]
H_ncs:
    s_lshr_b32 s41, s48, 16
    s_and_b32 s42, s41, 0x7fff
    s_xor_b32 s43, s41, 0xffff
    s_bitcmp1_b32 s41, 15
    s_cselect_b32 s41, s42, s43
    s_lshl_b32 s41, s41, 16
    v_mov_b32 v11, s41
    v_mul_f32 v11, 0xbfb8aa3b, v11
    v_exp_f32 v11, v11
    s_nop 0
    v_add_f32 v11, 1.0, v11
    v_rcp_f32 v11, v11
    s_nop 0
    v_cvt_pk_bf16_f32 v11, v11, v11
    v_lshlrev_b32 v11, 16, v11
    v_lshlrev_b32 v26, 16, v38
    v_and_b32 v27, 0xffff0000, v38
    v_lshlrev_b32 v28, 16, v39
    v_and_b32 v29, 0xffff0000, v39
    s_lshl_b32 s41, s47, 7
    s_add_u32 s41, s41, 4325376
    s_lshl_b32 s42, s52, 10
    s_lshl_b32 s43, s47, 2
    s_add_u32 s42, s42, s43
    s_cmp_eq_u32 s54, 0
    s_cselect_b32 s41, s41, s42
    v_mov_b32 v25, s41
    s_sleep 14
    s_mov_b32 s46, 0
    s_mov_b64 vcc, -1
H_hp:
    s_mov_b64 exec, vcc
    global_load_dwordx4 v[12:15], v2, s[32:33] sc1
    s_mov_b64 exec, -1
    s_waitcnt vmcnt(0)
    v_max3_u32 v9, v12, v13, v14
    v_max_u32 v9, v9, v15
    v_cmp_eq_u32 vcc, -1, v9
    s_cbranch_vccz H_hpd_61
    s_sleep 3
    s_add_u32 s46, s46, 1
    s_cmp_lt_u32 s46, 40000
    s_cbranch_scc1 H_hp
H_hpd_61:
    v_dot2_f32_bf16 v8, v56, v12, 0
    v_dot2_f32_bf16 v9, v60, v12, 0
    v_dot2_f32_bf16 v8, v57, v13, v8
    v_dot2_f32_bf16 v9, v61, v13, v9
    v_dot2_f32_bf16 v8, v58, v14, v8
    v_dot2_f32_bf16 v9, v62, v14, v9
    v_dot2_f32_bf16 v8, v59, v15, v8
    v_dot2_f32_bf16 v9, v63, v15, v9
    v_cmp_gt_u32 vcc, 224, v1
    s_nop 1
    v_cndmask_b32 v8, 0, v8, vcc
    v_cndmask_b32 v9, 0, v9, vcc
    s_nop 1
    v_permlane32_swap_b32 v8, v9
    v_add_f32 v8, v8, v9
    s_nop 1
    v_add_f32_dpp v8, v8, v8 row_ror:8 row_mask:0xf bank_mask:0xf
    s_nop 1
    v_add_f32_dpp v8, v8, v8 row_ror:4 row_mask:0xf bank_mask:0xf
    s_nop 1
    v_add_f32_dpp v8, v8, v8 row_ror:2 row_mask:0xf bank_mask:0xf
    s_nop 1
    v_add_f32_dpp v8, v8, v8 row_ror:1 row_mask:0xf bank_mask:0xf
    s_nop 1
    v_add_f32_dpp v8, v8, v8 row_bcast:15 row_mask:0xa bank_mask:0xf
    s_mov_b32 exec_lo, 0x80000000
    s_mov_b32 exec_hi, 0x80000000
    ds_write_b32 v24, v8
    s_mov_b64 exec, 1
    ds_add_rtn_u32 v10, v37, v23 offset:464
    s_mov_b64 exec, -1
    ds_read_b128 v[12:15], v3 offset:400
    ds_read_b128 v[16:19], v3 offset:416
    s_waitcnt lgkmcnt(0)
    v_readfirstlane_b32 s42, v10
    s_cmp_lg_u32 s42, 3
    s_cbranch_scc1 H_ffd
    v_pk_add_f32 v[12:13], v[12:13], v[14:15]
    v_pk_add_f32 v[16:17], v[16:17], v[18:19]
    v_pk_add_f32 v[8:9], v[12:13], v[16:17]
    v_cvt_pk_bf16_f32 v8, 0, v8
    v_cvt_pk_bf16_f32 v9, 0, v9
    v_mul_f32 v8, v8, v11
    v_mul_f32 v9, v9, v11
    v_cvt_pk_bf16_f32 v8, 0, v8
    v_cvt_pk_bf16_f32 v9, 0, v9
    v_pk_add_f32 v[8:9], v[8:9], v[26:27]
    v_cvt_pk_bf16_f32 v8, 0, v8
    v_cvt_pk_bf16_f32 v9, 0, v9
    v_pk_add_f32 v[8:9], v[8:9], v[28:29]
    v_cvt_pk_bf16_f32 v12, v8, v9
    s_mov_b64 exec, 1
    s_cmp_lg_u32 s54, 0
    s_cbranch_scc1 H_fo
    global_store_dword v25, v12, s[32:33] sc1
    s_branch H_fo2
H_fo:
    global_store_dword v25, v12, s[28:29]
H_fo2:
    s_mov_b64 exec, -1
H_ffd:
    s_cmp_lg_u32 s54, 0
    s_cbranch_scc1 L_end
    s_lshl_b32 s41, s51, 13
    s_add_u32 s41, s41, 4325376
    v_lshl_add_u32 v1, v0, 7, s41
    s_lshl_b32 s41, s51, 8
    s_add_u32 s41, s41, 140800
    v_lshl_add_u32 v2, v0, 2, s41
    s_mov_b32 s46, 0
    s_sleep 20
    s_mov_b64 vcc, -1
H_yw:
    s_mov_b64 exec, vcc
    global_load_dword v40, v1, s[32:33] sc1
    s_mov_b64 exec, -1
    s_waitcnt vmcnt(0)
    v_cmp_eq_u32 vcc, -1, v40
    s_cbranch_vccz H_yd_62
    s_sleep 3
    s_add_u32 s46, s46, 1
    s_cmp_lt_u32 s46, 40000
    s_cbranch_scc1 H_yw
H_yd_62:
    ds_write_b32 v2, v40
    v_mov_b32 v2, 1
    s_mov_b64 exec, 1
    ds_add_rtn_u32 v41, v3, v2 offset:548
    s_mov_b64 exec, -1
    v_lshlrev_b32 v1, 4, v0
    v_add_u32 v1, 139776, v1
    s_waitcnt lgkmcnt(0)
    v_readfirstlane_b32 s41, v41
    s_cmp_lg_u32 s41, 3
    s_cbranch_scc1 H_fx1
    ds_read_b128 v[40:43], v1 offset:1024
    s_waitcnt lgkmcnt(0)
    v_lshlrev_b32 v8, 16, v40
    v_and_b32 v9, 0xffff0000, v40
    v_lshlrev_b32 v10, 16, v41
    v_and_b32 v11, 0xffff0000, v41
    v_lshlrev_b32 v12, 16, v42
    v_and_b32 v13, 0xffff0000, v42
    v_lshlrev_b32 v14, 16, v43
    v_and_b32 v15, 0xffff0000, v43
    v_readfirstlane_b32 s42, v8
    s_nop 1
    v_pk_add_f32 v[16:17], v[8:9], s[42:43] op_sel_hi:[1,0] neg_lo:[0,1] neg_hi:[0,1]
    v_pk_add_f32 v[18:19], v[10:11], s[42:43] op_sel_hi:[1,0] neg_lo:[0,1] neg_hi:[0,1]
    v_pk_add_f32 v[20:21], v[12:13], s[42:43] op_sel_hi:[1,0] neg_lo:[0,1] neg_hi:[0,1]
    v_pk_add_f32 v[22:23], v[14:15], s[42:43] op_sel_hi:[1,0] neg_lo:[0,1] neg_hi:[0,1]
    v_pk_add_f32 v[24:25], v[16:17], v[18:19]
    v_pk_mul_f32 v[26:27], v[16:17], v[16:17]
    v_pk_add_f32 v[24:25], v[24:25], v[20:21]
    v_pk_fma_f32 v[26:27], v[18:19], v[18:19], v[26:27]
    v_pk_add_f32 v[24:25], v[24:25], v[22:23]
    v_pk_fma_f32 v[26:27], v[20:21], v[20:21], v[26:27]
    v_add_f32 v24, v24, v25
    v_pk_fma_f32 v[26:27], v[22:23], v[22:23], v[26:27]
    v_mul_f32 v24, 0x3b000000, v24
    v_add_f32 v25, v26, v27
    s_nop 0
    v_add_f32_dpp v24, v24, v24 row_ror:8 row_mask:0xf bank_mask:0xf
    v_add_f32_dpp v25, v25, v25 row_ror:8 row_mask:0xf bank_mask:0xf
    s_nop 0
    v_add_f32_dpp v24, v24, v24 row_ror:4 row_mask:0xf bank_mask:0xf
    v_add_f32_dpp v25, v25, v25 row_ror:4 row_mask:0xf bank_mask:0xf
    s_nop 0
    v_add_f32_dpp v24, v24, v24 row_ror:2 row_mask:0xf bank_mask:0xf
    v_add_f32_dpp v25, v25, v25 row_ror:2 row_mask:0xf bank_mask:0xf
    s_nop 0
    v_add_f32_dpp v24, v24, v24 row_ror:1 row_mask:0xf bank_mask:0xf
    v_add_f32_dpp v25, v25, v25 row_ror:1 row_mask:0xf bank_mask:0xf
    s_nop 0
    v_add_f32_dpp v24, v24, v24 row_bcast:15 row_mask:0xa bank_mask:0xf
    v_add_f32_dpp v25, v25, v25 row_bcast:15 row_mask:0xa bank_mask:0xf
    s_nop 0
    v_add_f32_dpp v24, v24, v24 row_bcast:31 row_mask:0xc bank_mask:0xf
    v_add_f32_dpp v25, v25, v25 row_bcast:31 row_mask:0xc bank_mask:0xf
    v_mul_f32 v25, 0x3b000000, v25
    v_fma_f32 v25, -v24, v24, v25
    v_max_f32 v25, 0, v25
    v_add_f32 v25, 0x3727c5ac, v25
    v_rsq_f32 v25, v25
    s_nop 0
    v_mul_f32 v24, v24, v25
    v_readlane_b32 s42, v25, 63
    v_readlane_b32 s43, v24, 63
    s_nop 1
    v_pk_fma_f32 v[16:17], v[16:17], s[42:43], s[42:43] op_sel:[0,0,1] op_sel_hi:[1,0,1] neg_lo:[0,0,1] neg_hi:[0,0,1]
    v_pk_fma_f32 v[18:19], v[18:19], s[42:43], s[42:43] op_sel:[0,0,1] op_sel_hi:[1,0,1] neg_lo:[0,0,1] neg_hi:[0,0,1]
    v_pk_fma_f32 v[20:21], v[20:21], s[42:43], s[42:43] op_sel:[0,0,1] op_sel_hi:[1,0,1] neg_lo:[0,0,1] neg_hi:[0,0,1]
    v_pk_fma_f32 v[22:23], v[22:23], s[42:43], s[42:43] op_sel:[0,0,1] op_sel_hi:[1,0,1] neg_lo:[0,0,1] neg_hi:[0,0,1]
    v_cvt_pk_bf16_f32 v28, v16, v17
    v_cvt_pk_bf16_f32 v29, v18, v19
    v_cvt_pk_bf16_f32 v30, v20, v21
    v_cvt_pk_bf16_f32 v31, v22, v23
    ds_write_b128 v1, v[28:31]
    v_mov_b32 v2, 1
    s_mov_b64 exec, 1
    ds_add_u32 v3, v2 offset:512
    s_mov_b64 exec, -1
H_fx1:
    s_xor_b32 s41, s52, s49
    s_lshr_b32 s41, s41, 5
    s_cbranch_scc1 H_fx2
    s_mov_b32 s46, 0
W_63:
    ds_read_b32 v2, v3 offset:512
    s_waitcnt lgkmcnt(0)
    v_cmp_gt_u32 vcc, 1, v2
    s_cbranch_vccz Wd_64
    s_sleep 2
    s_add_u32 s46, s46, 1
    s_cmp_lt_u32 s46, 320000
    s_cbranch_scc1 W_63
Wd_64:
    v_lshrrev_b32 v12, 4, v0
    v_bfe_u32 v13, v0, 2, 2
    v_lshl_add_u32 v1, v12, 3, v13
    v_and_b32 v12, 1, v12
    v_lshl_add_u32 v12, v12, 2, v13
    s_lshl_b32 s41, s51, 1
    v_xor_b32 v12, s41, v12
    v_and_b32 v13, 3, v0
    v_lshl_add_u32 v13, v12, 2, v13
    v_lshlrev_b32 v13, 3, v13
    v_lshl_add_u32 v1, v1, 8, v13
    v_lshrrev_b32 v12, 4, v0
    v_lshlrev_b32 v8, 4, v12
    v_add_u32 v8, 139776, v8
    v_add_u32 v9, 64, v8
    v_add_u32 v10, 128, v8
    v_add_u32 v11, 192, v8
    s_lshl_b32 s41, s37, 3
    s_sub_u32 s41, s52, s41
    s_sub_u32 s41, s41, 8
    s_and_b32 s41, s41, 31
    s_mul_i32 s41, s41, 272
    s_lshl_b32 s42, s51, 6
    s_add_u32 s41, s41, s42
    s_add_u32 s41, s41, 147456
    v_lshl_add_u32 v2, v12, 3, s41
    v_mov_b32 v3, 160748
    s_mov_b32 s97, 2
    s_branch H_qp
H_fx3:
    v_mov_b32 v3, 160768
    s_mov_b32 s46, 0
W_65:
    ds_read_b32 v2, v3 offset:516
    s_waitcnt lgkmcnt(0)
    v_cmp_gt_u32 vcc, 8, v2
    s_cbranch_vccz Wd_66
    s_sleep 1
    s_add_u32 s46, s46, 1
    s_cmp_lt_u32 s46, 320000
    s_cbranch_scc1 W_65
Wd_66:
H_fx2:
    s_lshl_b32 s98, s51, 14
    s_lshl_b32 s41, s51, 12
    v_lshl_add_u32 v1, v0, 4, s41
    s_mov_b32 m0, s98
    s_nop 0
    global_load_lds_dwordx4 v1, s[12:13] offset:0
    global_load_lds_dwordx4 v1, s[12:13] offset:1024
    global_load_lds_dwordx4 v1, s[12:13] offset:2048
    global_load_lds_dwordx4 v1, s[12:13] offset:3072
    s_add_u32 m0, s98, 4096
    s_nop 0
    global_load_lds_dwordx4 v1, s[14:15] offset:0
    global_load_lds_dwordx4 v1, s[14:15] offset:1024
    global_load_lds_dwordx4 v1, s[14:15] offset:2048
    global_load_lds_dwordx4 v1, s[14:15] offset:3072
    s_waitcnt vmcnt(0)
    v_lshrrev_b32 v1, 4, v0
    v_and_b32 v2, 15, v0
    v_lshlrev_b32 v2, 3, v2
    v_lshl_add_u32 v1, v1, 8, v2
    v_add_u32 v1, s98, v1
    ds_read_b64_tr_b16 v[8:9], v1 offset:0
    ds_read_b64_tr_b16 v[10:11], v1 offset:128
    ds_read_b64_tr_b16 v[12:13], v1 offset:4096
    ds_read_b64_tr_b16 v[14:15], v1 offset:4224
    ds_read_b64_tr_b16 v[16:17], v1 offset:1024
    ds_read_b64_tr_b16 v[18:19], v1 offset:1152
    ds_read_b64_tr_b16 v[20:21], v1 offset:5120
    ds_read_b64_tr_b16 v[22:23], v1 offset:5248
    ds_read_b64_tr_b16 v[24:25], v1 offset:2048
    ds_read_b64_tr_b16 v[26:27], v1 offset:2176
    ds_read_b64_tr_b16 v[28:29], v1 offset:6144
    ds_read_b64_tr_b16 v[30:31], v1 offset:6272
    s_waitcnt lgkmcnt(4)
    ds_read_b64_tr_b16 v[32:33], v1 offset:3072
    ds_read_b64_tr_b16 v[34:35], v1 offset:3200
    ds_read_b64_tr_b16 v[36:37], v1 offset:7168
    ds_read_b64_tr_b16 v[38:39], v1 offset:7296
    s_mov_b32 s46, 0
W_67:
    ds_read_b32 v2, v3 offset:512
    s_waitcnt lgkmcnt(0)
    v_cmp_gt_u32 vcc, 1, v2
    s_cbranch_vccz Wd_68
    s_sleep 2
    s_add_u32 s46, s46, 1
    s_cmp_lt_u32 s46, 320000
    s_cbranch_scc1 W_67
Wd_68:
    v_lshrrev_b32 v2, 4, v0
    s_lshl_b32 s41, s51, 8
    s_add_u32 s41, s41, 139776
    v_lshl_add_u32 v1, v2, 4, s41
    ds_read_b128 v[40:43], v1 offset:0
    ds_read_b128 v[44:47], v1 offset:64
    ds_read_b128 v[48:51], v1 offset:128
    ds_read_b128 v[52:55], v1 offset:192
    s_lshl_b32 s41, s51, 7
    s_add_u32 s41, s41, 141824
    v_lshl_add_u32 v2, v2, 4, s41
    s_waitcnt lgkmcnt(0)
    v_mfma_f32_16x16x32_bf16 v[56:59], v[8:11], v[40:43], 0
    v_mfma_f32_16x16x32_bf16 v[60:63], v[12:15], v[40:43], 0
    v_mfma_f32_16x16x32_bf16 v[56:59], v[16:19], v[44:47], v[56:59]
    v_mfma_f32_16x16x32_bf16 v[60:63], v[20:23], v[44:47], v[60:63]
    v_mfma_f32_16x16x32_bf16 v[56:59], v[24:27], v[48:51], v[56:59]
    v_mfma_f32_16x16x32_bf16 v[60:63], v[28:31], v[48:51], v[60:63]
    v_mfma_f32_16x16x32_bf16 v[56:59], v[32:35], v[52:55], v[56:59]
    v_mfma_f32_16x16x32_bf16 v[60:63], v[36:39], v[52:55], v[60:63]
    s_mov_b32 exec_lo, 0x00010001
    s_mov_b32 exec_hi, 0x00010001
    s_nop 4
    ds_write_b128 v2, v[56:59]
    ds_write_b128 v2, v[60:63] offset:64
    s_mov_b64 exec, -1
    s_lshl_b32 s41, s36, 4
    s_add_u32 s41, s41, 160768
    v_mov_b32 v8, s41
    v_mov_b32 v11, 160768
    v_mov_b32 v9, 1
    s_mov_b64 exec, 1
    ds_add_u32 v8, v9 offset:72
    s_mov_b64 exec, -1
    s_mov_b32 s46, 0
W_70:
    ds_read_b32 v9, v8 offset:72
    s_waitcnt lgkmcnt(0)
    v_cmp_gt_u32 vcc, 4, v9
    s_cbranch_vccz Wd_71
    s_sleep 3
    s_add_u32 s46, s46, 1
    s_cmp_lt_u32 s46, 320000
    s_cbranch_scc1 W_70
Wd_71:
    v_and_b32 v42, 7, v0
    v_lshlrev_b32 v1, 3, v42
    v_add_u32 v1, 141824, v1
    v_lshrrev_b32 v2, 5, v0
    s_and_b32 s41, s51, 1
    s_lshl_b32 s41, s41, 5
    s_add_u32 s41, s41, 141888
    v_lshl_add_u32 v40, v2, 4, s41
    s_lshl_b32 s41, s51, 5
    s_add_u32 s41, s41, 142336
    v_lshl_add_u32 v41, v2, 4, s41
    ds_read_b64 v[8:9], v1 offset:0
    ds_read_b64 v[10:11], v1 offset:128
    ds_read_b64 v[12:13], v1 offset:256
    ds_read_b64 v[14:15], v1 offset:384
    ds_read_b128 v[16:19], v40 offset:0
    ds_read_b128 v[20:23], v40 offset:128
    ds_read_b128 v[24:27], v40 offset:256
    ds_read_b128 v[28:31], v40 offset:384
    v_lshlrev_b32 v1, 2, v42
    v_add_u32 v1, 141824, v1
    s_waitcnt lgkmcnt(4)
    v_pk_add_f32 v[8:9], v[8:9], v[10:11]
    v_pk_add_f32 v[12:13], v[12:13], v[14:15]
    v_pk_add_f32 v[8:9], v[8:9], v[12:13]
    v_cvt_pk_bf16_f32 v8, v8, v9
    s_waitcnt lgkmcnt(0)
    v_pk_add_f32 v[16:17], v[16:17], v[20:21]
    v_pk_add_f32 v[18:19], v[18:19], v[22:23]
    v_pk_add_f32 v[24:25], v[24:25], v[28:29]
    v_pk_add_f32 v[26:27], v[26:27], v[30:31]
    v_pk_add_f32 v[16:17], v[16:17], v[24:25]
    v_pk_add_f32 v[18:19], v[18:19], v[26:27]
    v_readlane_b32 s0, v8, 0
    v_readlane_b32 s1, v8, 1
    v_readlane_b32 s2, v8, 2
    v_readlane_b32 s3, v8, 3
    v_readlane_b32 s4, v8, 4
    v_readlane_b32 s5, v8, 5
    v_readlane_b32 s6, v8, 6
    v_readlane_b32 s7, v8, 7
    v_cvt_pk_bf16_f32 v20, v16, v17
    v_cvt_pk_bf16_f32 v21, v18, v19
    v_lshlrev_b32 v16, 16, v20
    v_and_b32 v17, 0xffff0000, v20
    v_lshlrev_b32 v18, 16, v21
    v_and_b32 v19, 0xffff0000, v21
    ds_write_b128 v41, v[16:19]
    ds_write_b32 v1, v8 offset:768
    s_cmp_lg_u32 s49, 7
    s_cbranch_scc1 H_nE
    s_add_u32 s41, s34, 2
    v_mov_b32 v1, 0
    v_mov_b32 v2, s41
    s_mov_b64 exec, 1
    global_store_dword v1, v2, s[32:33] sc1
    s_mov_b64 exec, -1
H_nE:
    s_lshl_b32 s41, s47, 15
    s_lshl_b32 s42, s51, 13
    s_add_u32 s41, s41, s42
    s_add_u32 s41, s41, 33558528
    v_lshl_add_u32 v2, v0, 4, s41
    global_load_dwordx4 v[64:67], v2, s[32:33] offset:-4096 sc1
    global_load_dwordx4 v[68:71], v2, s[32:33] offset:-3072 sc1
    global_load_dwordx4 v[72:75], v2, s[32:33] offset:-2048 sc1
    global_load_dwordx4 v[76:79], v2, s[32:33] offset:-1024 sc1
    global_load_dwordx4 v[80:83], v2, s[32:33] offset:0 sc1
    global_load_dwordx4 v[84:87], v2, s[32:33] offset:1024 sc1
    s_branch H_bursts
H_toX:
    s_barrier
    s_barrier
H_slow:
    s_waitcnt vmcnt(0) lgkmcnt(0)
    s_barrier
    v_mov_b64 v[28:29], -1
    v_mov_b64 v[30:31], -1
    s_lshl_b32 s41, s51, 10
    s_add_u32 s41, s41, 156160
    v_lshl_add_u32 v1, v0, 4, s41
    ds_write_b128 v1, v[28:31]
    s_lshl_b32 s41, s51, 8
    s_add_u32 s41, s41, 142848
    v_lshl_add_u32 v1, v0, 2, s41
    v_mov_b32 v8, 0xff800000
    ds_write_b32 v1, v8
    s_lshl_b32 s41, s36, 4
    s_add_u32 s41, s41, 160768
    v_mov_b32 v1, s41
    v_mov_b32 v2, 160768
    v_mov_b64 v[8:9], 0
    ds_write_b64 v1, v[8:9] offset:64
    ds_write_b32 v2, v8 offset:96
    s_mov_b32 s19, 1
    s_waitcnt lgkmcnt(0)
    s_barrier
    s_barrier
    s_branch H_bursts
A_slow:
    s_waitcnt vmcnt(0)
    s_barrier
    s_cmp_eq_u32 s3, 15
    s_cbranch_scc1 A_sl1
    v_lshrrev_b32 v8, 5, v0
    v_lshlrev_b32 v8, 4, v8
    v_add_u32 v8, 142592, v8
    ds_read_b128 v[32:35], v8
    v_and_b32 v9, 15, v0
    v_lshlrev_b32 v9, 2, v9
    v_add_u32 v9, 142336, v9
    ds_read_b32 v36, v9
    v_and_b32 v9, 27, v0
    v_cmp_eq_u32 vcc, 16, v9
    v_mov_b32 v10, 0x3f800000
    s_nop 0
    v_cndmask_b32 v10, 0, v10, vcc
    v_and_b32 v9, 16, v0
    v_cmp_eq_u32 vcc, 0, v9
    s_waitcnt lgkmcnt(0)
    s_nop 0
    v_cndmask_b32 v36, v10, v36, vcc
    s_bitcmp1_b32 s52, 0
    s_cselect_b32 s41, 0, 16
    v_lshrrev_b32 v36, s41, v36
    s_mov_b64 exec, s[6:7]
    s_lshl_b32 s41, s3, 4
    s_add_u32 s41, s41, s4
    s_set_gpr_idx_on s41, gpr_idx(SRC0,DST)
    s_nop 1
    v_or_b32 v128, v128, v36
    s_nop 1
    s_set_gpr_idx_off
    s_bfe_u32 s41, s101, 0x20006
    s_lshl_b32 s41, s41, 3
    s_and_b32 s42, s52, 7
    s_add_u32 s41, s41, s42
    s_lshl_b32 s42, 1, s41
    s_mov_b32 exec_lo, s42
    s_mov_b32 exec_hi, s42
    s_bfe_u32 s41, s101, 0x10008
    s_lshl_b32 s42, s3, 1
    s_add_u32 s41, s41, s42
    s_lshl_b32 s41, s41, 2
    s_set_gpr_idx_on s41, gpr_idx(DST)
    s_nop 1
    v_mov_b32 v64, v32
    v_mov_b32 v65, v33
    v_mov_b32 v66, v34
    v_mov_b32 v67, v35
    s_nop 1
    s_set_gpr_idx_off
    s_mov_b64 exec, -1
A_sl1:
    v_and_b32 v14, 31, v0
    v_lshlrev_b32 v14, 2, v14
    v_add_u32 v14, 142848, v14
    v_bfe_u32 v1, v0, 3, 2
    v_mul_u32_u24 v1, 272, v1
    v_and_b32 v2, 7, v0
    v_lshl_add_u32 v1, v2, 5, v1
    v_lshrrev_b32 v2, 5, v0
    v_lshl_add_u32 v1, v2, 4, v1
    v_add_u32 v1, 147456, v1
    s_lshl_b32 s50, s51, 11
    s_add_u32 s50, s50, 1796
    v_mov_b32 v3, 0xdddddddd
    v_and_b32 v0, 31, v0
    s_lshl_b32 s41, s51, 7
    s_add_u32 s41, s41, 156160
    v_lshl_add_u32 v0, v0, 2, s41
    s_barrier
    s_mov_b32 s44, 0
A_sm:
    s_mul_i32 s41, s44, 1088
    v_add_u32 v8, s41, v1
    ds_read_b128 v[8:11], v8
    v_mov_b32 v15, 0xff800000
    s_waitcnt lgkmcnt(0)
    v_mfma_f32_32x32x16_bf16 v[32:47], v[64:67], v[8:11], 0
    s_nop 11
    v_max3_f32 v15, v15, v32, v33
    v_max3_f32 v15, v15, v34, v35
    v_max3_f32 v15, v15, v36, v37
    v_max3_f32 v15, v15, v38, v39
    v_max3_f32 v15, v15, v40, v41
    v_max3_f32 v15, v15, v42, v43
    v_max3_f32 v15, v15, v44, v45
    v_max3_f32 v15, v15, v46, v47
    v_mfma_f32_32x32x16_bf16 v[32:47], v[68:71], v[8:11], 0
    s_nop 11
    v_max3_f32 v15, v15, v32, v33
    v_max3_f32 v15, v15, v34, v35
    v_max3_f32 v15, v15, v36, v37
    v_max3_f32 v15, v15, v38, v39
    v_max3_f32 v15, v15, v40, v41
    v_max3_f32 v15, v15, v42, v43
    v_max3_f32 v15, v15, v44, v45
    v_max3_f32 v15, v15, v46, v47
    v_mfma_f32_32x32x16_bf16 v[32:47], v[72:75], v[8:11], 0
    s_nop 11
    v_max3_f32 v15, v15, v32, v33
    v_max3_f32 v15, v15, v34, v35
    v_max3_f32 v15, v15, v36, v37
    v_max3_f32 v15, v15, v38, v39
    v_max3_f32 v15, v15, v40, v41
    v_max3_f32 v15, v15, v42, v43
    v_max3_f32 v15, v15, v44, v45
    v_max3_f32 v15, v15, v46, v47
    v_mfma_f32_32x32x16_bf16 v[32:47], v[76:79], v[8:11], 0
    s_nop 11
    v_max3_f32 v15, v15, v32, v33
    v_max3_f32 v15, v15, v34, v35
    v_max3_f32 v15, v15, v36, v37
    v_max3_f32 v15, v15, v38, v39
    v_max3_f32 v15, v15, v40, v41
    v_max3_f32 v15, v15, v42, v43
    v_max3_f32 v15, v15, v44, v45
    v_max3_f32 v15, v15, v46, v47
    v_mfma_f32_32x32x16_bf16 v[32:47], v[80:83], v[8:11], 0
    s_nop 11
    v_max3_f32 v15, v15, v32, v33
    v_max3_f32 v15, v15, v34, v35
    v_max3_f32 v15, v15, v36, v37
    v_max3_f32 v15, v15, v38, v39
    v_max3_f32 v15, v15, v40, v41
    v_max3_f32 v15, v15, v42, v43
    v_max3_f32 v15, v15, v44, v45
    v_max3_f32 v15, v15, v46, v47
    v_mfma_f32_32x32x16_bf16 v[32:47], v[84:87], v[8:11], 0
    s_nop 11
    v_max3_f32 v15, v15, v32, v33
    v_max3_f32 v15, v15, v34, v35
    v_max3_f32 v15, v15, v36, v37
    v_max3_f32 v15, v15, v38, v39
    v_max3_f32 v15, v15, v40, v41
    v_max3_f32 v15, v15, v42, v43
    v_max3_f32 v15, v15, v44, v45
    v_max3_f32 v15, v15, v46, v47
    v_mfma_f32_32x32x16_bf16 v[32:47], v[88:91], v[8:11], 0
    s_nop 11
    v_max3_f32 v15, v15, v32, v33
    v_max3_f32 v15, v15, v34, v35
    v_max3_f32 v15, v15, v36, v37
    v_max3_f32 v15, v15, v38, v39
    v_max3_f32 v15, v15, v40, v41
    v_max3_f32 v15, v15, v42, v43
    v_max3_f32 v15, v15, v44, v45
    v_max3_f32 v15, v15, v46, v47
    v_mfma_f32_32x32x16_bf16 v[32:47], v[92:95], v[8:11], 0
    s_nop 11
    v_max3_f32 v15, v15, v32, v33
    v_max3_f32 v15, v15, v34, v35
    v_max3_f32 v15, v15, v36, v37
    v_max3_f32 v15, v15, v38, v39
    v_max3_f32 v15, v15, v40, v41
    v_max3_f32 v15, v15, v42, v43
    v_max3_f32 v15, v15, v44, v45
    v_max3_f32 v15, v15, v46, v47
    v_mfma_f32_32x32x16_bf16 v[32:47], v[96:99], v[8:11], 0
    s_nop 11
    v_max3_f32 v15, v15, v32, v33
    v_max3_f32 v15, v15, v34, v35
    v_max3_f32 v15, v15, v36, v37
    v_max3_f32 v15, v15, v38, v39
    v_max3_f32 v15, v15, v40, v41
    v_max3_f32 v15, v15, v42, v43
    v_max3_f32 v15, v15, v44, v45
    v_max3_f32 v15, v15, v46, v47
    v_mfma_f32_32x32x16_bf16 v[32:47], v[100:103], v[8:11], 0
    s_nop 11
    v_max3_f32 v15, v15, v32, v33
    v_max3_f32 v15, v15, v34, v35
    v_max3_f32 v15, v15, v36, v37
    v_max3_f32 v15, v15, v38, v39
    v_max3_f32 v15, v15, v40, v41
    v_max3_f32 v15, v15, v42, v43
    v_max3_f32 v15, v15, v44, v45
    v_max3_f32 v15, v15, v46, v47
    v_mfma_f32_32x32x16_bf16 v[32:47], v[104:107], v[8:11], 0
    s_nop 11
    v_max3_f32 v15, v15, v32, v33
    v_max3_f32 v15, v15, v34, v35
    v_max3_f32 v15, v15, v36, v37
    v_max3_f32 v15, v15, v38, v39
    v_max3_f32 v15, v15, v40, v41
    v_max3_f32 v15, v15, v42, v43
    v_max3_f32 v15, v15, v44, v45
    v_max3_f32 v15, v15, v46, v47
    v_mfma_f32_32x32x16_bf16 v[32:47], v[108:111], v[8:11], 0
    s_nop 11
    v_max3_f32 v15, v15, v32, v33
    v_max3_f32 v15, v15, v34, v35
    v_max3_f32 v15, v15, v36, v37
    v_max3_f32 v15, v15, v38, v39
    v_max3_f32 v15, v15, v40, v41
    v_max3_f32 v15, v15, v42, v43
    v_max3_f32 v15, v15, v44, v45
    v_max3_f32 v15, v15, v46, v47
    v_mfma_f32_32x32x16_bf16 v[32:47], v[112:115], v[8:11], 0
    s_nop 11
    v_max3_f32 v15, v15, v32, v33
    v_max3_f32 v15, v15, v34, v35
    v_max3_f32 v15, v15, v36, v37
    v_max3_f32 v15, v15, v38, v39
    v_max3_f32 v15, v15, v40, v41
    v_max3_f32 v15, v15, v42, v43
    v_max3_f32 v15, v15, v44, v45
    v_max3_f32 v15, v15, v46, v47
    v_mfma_f32_32x32x16_bf16 v[32:47], v[116:119], v[8:11], 0
    s_nop 11
    v_max3_f32 v15, v15, v32, v33
    v_max3_f32 v15, v15, v34, v35
    v_max3_f32 v15, v15, v36, v37
    v_max3_f32 v15, v15, v38, v39
    v_max3_f32 v15, v15, v40, v41
    v_max3_f32 v15, v15, v42, v43
    v_max3_f32 v15, v15, v44, v45
    v_max3_f32 v15, v15, v46, v47
    v_mfma_f32_32x32x16_bf16 v[32:47], v[120:123], v[8:11], 0
    s_nop 11
    v_max3_f32 v15, v15, v32, v33
    v_max3_f32 v15, v15, v34, v35
    v_max3_f32 v15, v15, v36, v37
    v_max3_f32 v15, v15, v38, v39
    v_max3_f32 v15, v15, v40, v41
    v_max3_f32 v15, v15, v42, v43
    v_max3_f32 v15, v15, v44, v45
    v_max3_f32 v15, v15, v46, v47
    v_mfma_f32_32x32x16_bf16 v[32:47], v[124:127], v[8:11], 0
    s_nop 11
    v_max3_f32 v15, v15, v32, v33
    v_max3_f32 v15, v15, v34, v35
    v_max3_f32 v15, v15, v36, v37
    v_max3_f32 v15, v15, v38, v39
    v_max3_f32 v15, v15, v40, v41
    v_max3_f32 v15, v15, v42, v43
    v_max3_f32 v15, v15, v44, v45
    v_max3_f32 v15, v15, v46, v47
    v_lshl_add_u32 v13, s44, 7, v14
    ds_max_f32 v13, v15
    s_add_u32 s44, s44, 1
    s_cmp_lt_u32 s44, 8
    s_cbranch_scc1 A_sm
    s_waitcnt lgkmcnt(0)
    s_barrier
    s_mov_b32 s44, 0
A_se:
    s_mul_i32 s41, s44, 1088
    v_add_u32 v8, s41, v1
    ds_read_b128 v[8:11], v8
    v_lshl_add_u32 v13, s44, 7, v14
    ds_read_b32 v15, v13
    s_waitcnt lgkmcnt(0)
    v_sub_f32 v48, 0, v15
    v_sub_f32 v49, 0, v15
    v_sub_f32 v50, 0, v15
    v_sub_f32 v51, 0, v15
    v_sub_f32 v52, 0, v15
    v_sub_f32 v53, 0, v15
    v_sub_f32 v54, 0, v15
    v_sub_f32 v55, 0, v15
    v_sub_f32 v56, 0, v15
    v_sub_f32 v57, 0, v15
    v_sub_f32 v58, 0, v15
    v_sub_f32 v59, 0, v15
    v_sub_f32 v60, 0, v15
    v_sub_f32 v61, 0, v15
    v_sub_f32 v62, 0, v15
    v_sub_f32 v63, 0, v15
    v_mov_b64 v[16:17], 0
    v_mov_b64 v[18:19], 0
    v_mov_b64 v[20:21], 0
    v_mov_b64 v[22:23], 0
    v_mov_b64 v[24:25], 0
    v_mov_b64 v[26:27], 0
    v_mov_b64 v[28:29], 0
    v_mov_b64 v[30:31], 0
    v_mfma_f32_32x32x16_bf16 v[32:47], v[64:67], v[8:11], v[48:63]
    s_nop 11
    v_exp_f32 v32, v32
    v_exp_f32 v33, v33
    v_exp_f32 v34, v34
    v_exp_f32 v35, v35
    v_exp_f32 v36, v36
    v_exp_f32 v37, v37
    v_exp_f32 v38, v38
    v_exp_f32 v39, v39
    v_exp_f32 v40, v40
    v_exp_f32 v41, v41
    v_exp_f32 v42, v42
    v_exp_f32 v43, v43
    v_exp_f32 v44, v44
    v_exp_f32 v45, v45
    v_exp_f32 v46, v46
    v_exp_f32 v47, v47
    v_smfmac_f32_32x32x32_bf16 v[16:31], v[128:131], v[32:39], v3
    s_nop 0
    v_smfmac_f32_32x32x32_bf16 v[16:31], v[132:135], v[40:47], v3
    v_mfma_f32_32x32x16_bf16 v[32:47], v[68:71], v[8:11], v[48:63]
    s_nop 11
    v_exp_f32 v32, v32
    v_exp_f32 v33, v33
    v_exp_f32 v34, v34
    v_exp_f32 v35, v35
    v_exp_f32 v36, v36
    v_exp_f32 v37, v37
    v_exp_f32 v38, v38
    v_exp_f32 v39, v39
    v_exp_f32 v40, v40
    v_exp_f32 v41, v41
    v_exp_f32 v42, v42
    v_exp_f32 v43, v43
    v_exp_f32 v44, v44
    v_exp_f32 v45, v45
    v_exp_f32 v46, v46
    v_exp_f32 v47, v47
    v_smfmac_f32_32x32x32_bf16 v[16:31], v[136:139], v[32:39], v3
    s_nop 0
    v_smfmac_f32_32x32x32_bf16 v[16:31], v[140:143], v[40:47], v3
    v_mfma_f32_32x32x16_bf16 v[32:47], v[72:75], v[8:11], v[48:63]
    s_nop 11
    v_exp_f32 v32, v32
    v_exp_f32 v33, v33
    v_exp_f32 v34, v34
    v_exp_f32 v35, v35
    v_exp_f32 v36, v36
    v_exp_f32 v37, v37
    v_exp_f32 v38, v38
    v_exp_f32 v39, v39
    v_exp_f32 v40, v40
    v_exp_f32 v41, v41
    v_exp_f32 v42, v42
    v_exp_f32 v43, v43
    v_exp_f32 v44, v44
    v_exp_f32 v45, v45
    v_exp_f32 v46, v46
    v_exp_f32 v47, v47
    v_smfmac_f32_32x32x32_bf16 v[16:31], v[144:147], v[32:39], v3
    s_nop 0
    v_smfmac_f32_32x32x32_bf16 v[16:31], v[148:151], v[40:47], v3
    v_mfma_f32_32x32x16_bf16 v[32:47], v[76:79], v[8:11], v[48:63]
    s_nop 11
    v_exp_f32 v32, v32
    v_exp_f32 v33, v33
    v_exp_f32 v34, v34
    v_exp_f32 v35, v35
    v_exp_f32 v36, v36
    v_exp_f32 v37, v37
    v_exp_f32 v38, v38
    v_exp_f32 v39, v39
    v_exp_f32 v40, v40
    v_exp_f32 v41, v41
    v_exp_f32 v42, v42
    v_exp_f32 v43, v43
    v_exp_f32 v44, v44
    v_exp_f32 v45, v45
    v_exp_f32 v46, v46
    v_exp_f32 v47, v47
    v_smfmac_f32_32x32x32_bf16 v[16:31], v[152:155], v[32:39], v3
    s_nop 0
    v_smfmac_f32_32x32x32_bf16 v[16:31], v[156:159], v[40:47], v3
    v_mfma_f32_32x32x16_bf16 v[32:47], v[80:83], v[8:11], v[48:63]
    s_nop 11
    v_exp_f32 v32, v32
    v_exp_f32 v33, v33
    v_exp_f32 v34, v34
    v_exp_f32 v35, v35
    v_exp_f32 v36, v36
    v_exp_f32 v37, v37
    v_exp_f32 v38, v38
    v_exp_f32 v39, v39
    v_exp_f32 v40, v40
    v_exp_f32 v41, v41
    v_exp_f32 v42, v42
    v_exp_f32 v43, v43
    v_exp_f32 v44, v44
    v_exp_f32 v45, v45
    v_exp_f32 v46, v46
    v_exp_f32 v47, v47
    v_smfmac_f32_32x32x32_bf16 v[16:31], v[160:163], v[32:39], v3
    s_nop 0
    v_smfmac_f32_32x32x32_bf16 v[16:31], v[164:167], v[40:47], v3
    v_mfma_f32_32x32x16_bf16 v[32:47], v[84:87], v[8:11], v[48:63]
    s_nop 11
    v_exp_f32 v32, v32
    v_exp_f32 v33, v33
    v_exp_f32 v34, v34
    v_exp_f32 v35, v35
    v_exp_f32 v36, v36
    v_exp_f32 v37, v37
    v_exp_f32 v38, v38
    v_exp_f32 v39, v39
    v_exp_f32 v40, v40
    v_exp_f32 v41, v41
    v_exp_f32 v42, v42
    v_exp_f32 v43, v43
    v_exp_f32 v44, v44
    v_exp_f32 v45, v45
    v_exp_f32 v46, v46
    v_exp_f32 v47, v47
    v_smfmac_f32_32x32x32_bf16 v[16:31], v[168:171], v[32:39], v3
    s_nop 0
    v_smfmac_f32_32x32x32_bf16 v[16:31], v[172:175], v[40:47], v3
    v_mfma_f32_32x32x16_bf16 v[32:47], v[88:91], v[8:11], v[48:63]
    s_nop 11
    v_exp_f32 v32, v32
    v_exp_f32 v33, v33
    v_exp_f32 v34, v34
    v_exp_f32 v35, v35
    v_exp_f32 v36, v36
    v_exp_f32 v37, v37
    v_exp_f32 v38, v38
    v_exp_f32 v39, v39
    v_exp_f32 v40, v40
    v_exp_f32 v41, v41
    v_exp_f32 v42, v42
    v_exp_f32 v43, v43
    v_exp_f32 v44, v44
    v_exp_f32 v45, v45
    v_exp_f32 v46, v46
    v_exp_f32 v47, v47
    v_smfmac_f32_32x32x32_bf16 v[16:31], v[176:179], v[32:39], v3
    s_nop 0
    v_smfmac_f32_32x32x32_bf16 v[16:31], v[180:183], v[40:47], v3
    v_mfma_f32_32x32x16_bf16 v[32:47], v[92:95], v[8:11], v[48:63]
    s_nop 11
    v_exp_f32 v32, v32
    v_exp_f32 v33, v33
    v_exp_f32 v34, v34
    v_exp_f32 v35, v35
    v_exp_f32 v36, v36
    v_exp_f32 v37, v37
    v_exp_f32 v38, v38
    v_exp_f32 v39, v39
    v_exp_f32 v40, v40
    v_exp_f32 v41, v41
    v_exp_f32 v42, v42
    v_exp_f32 v43, v43
    v_exp_f32 v44, v44
    v_exp_f32 v45, v45
    v_exp_f32 v46, v46
    v_exp_f32 v47, v47
    v_smfmac_f32_32x32x32_bf16 v[16:31], v[184:187], v[32:39], v3
    s_nop 0
    v_smfmac_f32_32x32x32_bf16 v[16:31], v[188:191], v[40:47], v3
    v_mfma_f32_32x32x16_bf16 v[32:47], v[96:99], v[8:11], v[48:63]
    s_nop 11
    v_exp_f32 v32, v32
    v_exp_f32 v33, v33
    v_exp_f32 v34, v34
    v_exp_f32 v35, v35
    v_exp_f32 v36, v36
    v_exp_f32 v37, v37
    v_exp_f32 v38, v38
    v_exp_f32 v39, v39
    v_exp_f32 v40, v40
    v_exp_f32 v41, v41
    v_exp_f32 v42, v42
    v_exp_f32 v43, v43
    v_exp_f32 v44, v44
    v_exp_f32 v45, v45
    v_exp_f32 v46, v46
    v_exp_f32 v47, v47
    v_smfmac_f32_32x32x32_bf16 v[16:31], v[192:195], v[32:39], v3
    s_nop 0
    v_smfmac_f32_32x32x32_bf16 v[16:31], v[196:199], v[40:47], v3
    v_mfma_f32_32x32x16_bf16 v[32:47], v[100:103], v[8:11], v[48:63]
    s_nop 11
    v_exp_f32 v32, v32
    v_exp_f32 v33, v33
    v_exp_f32 v34, v34
    v_exp_f32 v35, v35
    v_exp_f32 v36, v36
    v_exp_f32 v37, v37
    v_exp_f32 v38, v38
    v_exp_f32 v39, v39
    v_exp_f32 v40, v40
    v_exp_f32 v41, v41
    v_exp_f32 v42, v42
    v_exp_f32 v43, v43
    v_exp_f32 v44, v44
    v_exp_f32 v45, v45
    v_exp_f32 v46, v46
    v_exp_f32 v47, v47
    v_smfmac_f32_32x32x32_bf16 v[16:31], v[200:203], v[32:39], v3
    s_nop 0
    v_smfmac_f32_32x32x32_bf16 v[16:31], v[204:207], v[40:47], v3
    v_mfma_f32_32x32x16_bf16 v[32:47], v[104:107], v[8:11], v[48:63]
    s_nop 11
    v_exp_f32 v32, v32
    v_exp_f32 v33, v33
    v_exp_f32 v34, v34
    v_exp_f32 v35, v35
    v_exp_f32 v36, v36
    v_exp_f32 v37, v37
    v_exp_f32 v38, v38
    v_exp_f32 v39, v39
    v_exp_f32 v40, v40
    v_exp_f32 v41, v41
    v_exp_f32 v42, v42
    v_exp_f32 v43, v43
    v_exp_f32 v44, v44
    v_exp_f32 v45, v45
    v_exp_f32 v46, v46
    v_exp_f32 v47, v47
    v_smfmac_f32_32x32x32_bf16 v[16:31], v[208:211], v[32:39], v3
    s_nop 0
    v_smfmac_f32_32x32x32_bf16 v[16:31], v[212:215], v[40:47], v3
    v_mfma_f32_32x32x16_bf16 v[32:47], v[108:111], v[8:11], v[48:63]
    s_nop 11
    v_exp_f32 v32, v32
    v_exp_f32 v33, v33
    v_exp_f32 v34, v34
    v_exp_f32 v35, v35
    v_exp_f32 v36, v36
    v_exp_f32 v37, v37
    v_exp_f32 v38, v38
    v_exp_f32 v39, v39
    v_exp_f32 v40, v40
    v_exp_f32 v41, v41
    v_exp_f32 v42, v42
    v_exp_f32 v43, v43
    v_exp_f32 v44, v44
    v_exp_f32 v45, v45
    v_exp_f32 v46, v46
    v_exp_f32 v47, v47
    v_smfmac_f32_32x32x32_bf16 v[16:31], v[216:219], v[32:39], v3
    s_nop 0
    v_smfmac_f32_32x32x32_bf16 v[16:31], v[220:223], v[40:47], v3
    v_mfma_f32_32x32x16_bf16 v[32:47], v[112:115], v[8:11], v[48:63]
    s_nop 11
    v_exp_f32 v32, v32
    v_exp_f32 v33, v33
    v_exp_f32 v34, v34
    v_exp_f32 v35, v35
    v_exp_f32 v36, v36
    v_exp_f32 v37, v37
    v_exp_f32 v38, v38
    v_exp_f32 v39, v39
    v_exp_f32 v40, v40
    v_exp_f32 v41, v41
    v_exp_f32 v42, v42
    v_exp_f32 v43, v43
    v_exp_f32 v44, v44
    v_exp_f32 v45, v45
    v_exp_f32 v46, v46
    v_exp_f32 v47, v47
    v_smfmac_f32_32x32x32_bf16 v[16:31], v[224:227], v[32:39], v3
    s_nop 0
    v_smfmac_f32_32x32x32_bf16 v[16:31], v[228:231], v[40:47], v3
    v_mfma_f32_32x32x16_bf16 v[32:47], v[116:119], v[8:11], v[48:63]
    s_nop 11
    v_exp_f32 v32, v32
    v_exp_f32 v33, v33
    v_exp_f32 v34, v34
    v_exp_f32 v35, v35
    v_exp_f32 v36, v36
    v_exp_f32 v37, v37
    v_exp_f32 v38, v38
    v_exp_f32 v39, v39
    v_exp_f32 v40, v40
    v_exp_f32 v41, v41
    v_exp_f32 v42, v42
    v_exp_f32 v43, v43
    v_exp_f32 v44, v44
    v_exp_f32 v45, v45
    v_exp_f32 v46, v46
    v_exp_f32 v47, v47
    v_smfmac_f32_32x32x32_bf16 v[16:31], v[232:235], v[32:39], v3
    s_nop 0
    v_smfmac_f32_32x32x32_bf16 v[16:31], v[236:239], v[40:47], v3
    v_mfma_f32_32x32x16_bf16 v[32:47], v[120:123], v[8:11], v[48:63]
    s_nop 11
    v_exp_f32 v32, v32
    v_exp_f32 v33, v33
    v_exp_f32 v34, v34
    v_exp_f32 v35, v35
    v_exp_f32 v36, v36
    v_exp_f32 v37, v37
    v_exp_f32 v38, v38
    v_exp_f32 v39, v39
    v_exp_f32 v40, v40
    v_exp_f32 v41, v41
    v_exp_f32 v42, v42
    v_exp_f32 v43, v43
    v_exp_f32 v44, v44
    v_exp_f32 v45, v45
    v_exp_f32 v46, v46
    v_exp_f32 v47, v47
    v_smfmac_f32_32x32x32_bf16 v[16:31], v[240:243], v[32:39], v3
    s_nop 0
    v_smfmac_f32_32x32x32_bf16 v[16:31], v[244:247], v[40:47], v3
    v_mfma_f32_32x32x16_bf16 v[32:47], v[124:127], v[8:11], v[48:63]
    s_nop 11
    v_exp_f32 v32, v32
    v_exp_f32 v33, v33
    v_exp_f32 v34, v34
    v_exp_f32 v35, v35
    v_exp_f32 v36, v36
    v_exp_f32 v37, v37
    v_exp_f32 v38, v38
    v_exp_f32 v39, v39
    v_exp_f32 v40, v40
    v_exp_f32 v41, v41
    v_exp_f32 v42, v42
    v_exp_f32 v43, v43
    v_exp_f32 v44, v44
    v_exp_f32 v45, v45
    v_exp_f32 v46, v46
    v_exp_f32 v47, v47
    v_smfmac_f32_32x32x32_bf16 v[16:31], v[248:251], v[32:39], v3
    s_nop 0
    v_smfmac_f32_32x32x32_bf16 v[16:31], v[252:255], v[40:47], v3
    s_mov_b32 s41, s44
    s_lshl_b32 s42, s41, 13
    s_add_u32 m0, s42, s50
    v_lshl_add_u32 v2, s41, 9, v0
    s_nop 7
    ds_write_addtid_b32 v16 offset:63740
    ds_write_addtid_b32 v17 offset:63996
    ds_write_addtid_b32 v18 offset:64252
    ds_write_addtid_b32 v19 offset:64508
    ds_write_addtid_b32 v20 offset:64764
    ds_write_addtid_b32 v21 offset:65020
    ds_write_addtid_b32 v22 offset:65276
    ds_write_addtid_b32 v23 offset:65532
    ds_write_b32 v2, v24
    s_add_u32 s44, s44, 1
    s_cmp_lt_u32 s44, 8
    s_cbranch_scc1 A_se
    s_branch A_X
L_end:
L_exit:
    s_endpgm
.section .rodata,"a"
.p2align 6
.amdhsa_kernel interleave_layers__grouped_kv_mqa__moe_arch_mod__prompt_kernel
  .amdhsa_next_free_vgpr 256
  .amdhsa_next_free_sgpr 102
  .amdhsa_accum_offset 256
  .amdhsa_group_segment_fixed_size 0
  .amdhsa_kernarg_size 104
  .amdhsa_user_sgpr_count 2
  .amdhsa_user_sgpr_kernarg_segment_ptr 1
  .amdhsa_system_sgpr_workgroup_id_x 1
  .amdhsa_float_denorm_mode_32 3
.end_amdhsa_kernel
```
